```python
import torch

def _softmax(x, axis=-1):
    return torch.softmax(x, dim=axis)
def _gelu(x):
    return torch.nn.functional.gelu(x, approximate="tanh")
def _silu(x):
    return torch.nn.functional.silu(x)
def _sigmoid(x):
    return torch.sigmoid(x)
def _layernorm(x, axis=-1, eps=1e-5):
    m = x.mean(dim=axis, keepdim=True)
    v = x.var(dim=axis, keepdim=True, unbiased=False)
    return (x - m) / torch.sqrt(v + eps)
def _scatter_add(tgt, idx, src, axis=0):
    return tgt.clone().index_add_(axis, idx, src)
def _segment_sum(src, seg, n):
    out = torch.zeros((n,) + src.shape[1:], dtype=src.dtype)
    return out.index_add_(0, seg, src)
def _pad(x, pw):
    flat = tuple(v for pair in reversed(pw) for v in pair)
    return torch.nn.functional.pad(x, flat)

kernel_name = 'concat_heads__compressed_kv_cla__ssm_conv_s4__prompt'

def setup_inputs():

    _w = (lambda a: (lambda t: t.to(torch.bfloat16) if t.is_floating_point() else t)(torch.as_tensor(a)))
    def _A_setup():
        B, H, Sq, Sk, D, M = 1, 32, 2048, 2048, 128, 512
        Dc = 4 * D
        return {
            "x": _w((lambda *s: torch.randn(*s, dtype=torch.bfloat16) * 3.2)(B, Sq, M)),
            "c_kv": _w((lambda *s: torch.randn(*s, dtype=torch.bfloat16) * 0.1)(B, Sk, Dc)),
            "w_q": _w((lambda *s: torch.randn(*s, dtype=torch.bfloat16) * 6.4)(M, H, D) * (M ** -0.5)),
            "w_uk": _w((lambda *s: torch.randn(*s, dtype=torch.bfloat16) * 6.4)(Dc, H, D) * (Dc ** -0.5)),
            "w_uv": _w((lambda *s: torch.randn(*s, dtype=torch.bfloat16) * 0.1)(Dc, H, D) * (Dc ** -0.5)),
            "w_o": _w((lambda *s: torch.randn(*s, dtype=torch.bfloat16) * 0.1)(H, D, M) * ((H * D) ** -0.5)),
        }
    _A_in = _A_setup()

    def _B_setup():
        B, L, D, N = 1, 2048, 512, 128
        A_re = -(lambda _x: torch.exp(torch.as_tensor(_x)))((lambda *s: torch.randn(*s, dtype=torch.bfloat16) * 3.2)(D, N))
        A_im = torch.pi * (lambda *s: torch.randn(*s, dtype=torch.bfloat16) * 0.05)(D, N)
        B_re = (lambda *s: torch.randn(*s, dtype=torch.bfloat16) * 0.1)(D, N)
        B_im = (lambda *s: torch.randn(*s, dtype=torch.bfloat16) * 0.1)(D, N)
        C_re = (lambda *s: torch.randn(*s, dtype=torch.bfloat16) * 0.1)(D, N)
        C_im = (lambda *s: torch.randn(*s, dtype=torch.bfloat16) * 0.1)(D, N)
        log_dt = (lambda *s: torch.randn(*s, dtype=torch.bfloat16) * 0.05)(D) * 0.5 - 4.0
        Dskip = (lambda *s: torch.randn(*s, dtype=torch.bfloat16) * 0.05)(D)
        return {
            "u": _w((lambda *s: torch.randn(*s, dtype=torch.bfloat16) * 0.05)(B, L, D)),
            "A_re": _w(A_re),
            "A_im": _w(A_im),
            "B_re": _w(B_re),
            "B_im": _w(B_im),
            "C_re": _w(C_re),
            "C_im": _w(C_im),
            "log_dt": _w(log_dt),
            "Dskip": _w(Dskip),
        }
    _B_in = _B_setup()

    return {
        "A_x": _A_in["x"],
        "A_c_kv": _A_in["c_kv"],
        "A_w_q": _A_in["w_q"],
        "A_w_uk": _A_in["w_uk"],
        "A_w_uv": _A_in["w_uv"],
        "A_w_o": _A_in["w_o"],
        "B_u": _B_in["u"],
        "B_A_re": _B_in["A_re"],
        "B_A_im": _B_in["A_im"],
        "B_B_re": _B_in["B_re"],
        "B_B_im": _B_in["B_im"],
        "B_C_re": _B_in["C_re"],
        "B_C_im": _B_in["C_im"],
        "B_log_dt": _B_in["log_dt"],
        "B_Dskip": _B_in["Dskip"],
    }

def reference(A_x, A_c_kv, A_w_q, A_w_uk, A_w_uv, A_w_o, B_u, B_A_re, B_A_im, B_B_re, B_B_im, B_C_re, B_C_im, B_log_dt, B_Dskip):
    def _A_ref(x, c_kv, w_q, w_uk, w_uv, w_o):
        B, Sq, M = x.shape[0], x.shape[1], x.shape[2]
        Sk = c_kv.shape[1]
        H, D = w_q.shape[1], w_q.shape[2]
        q = torch.einsum("bqm,mhd->bhqd", x, w_q)
        k = torch.einsum("bkc,chd->bhkd", c_kv, w_uk)
        v = torch.einsum("bkc,chd->bhkd", c_kv, w_uv)
        scores = torch.einsum("bhqd,bhkd->bhqk", q, k) * (D ** -0.5)
        off = Sk - Sq
        qi = torch.arange(Sq)[:, None]
        kj = torch.arange(Sk)[None, :]
        cmask = kj <= (qi + off)
        scores = torch.where(cmask[None, None], scores, -1e9)
        p = _softmax(scores, axis=-1)
        ctx = torch.einsum("bhqk,bhkd->bhqd", p, v)
        return torch.einsum("bhqd,hdm->bqm", ctx, w_o)

    def _B_ref(u, A_re, A_im, B_re, B_im, C_re, C_im, log_dt, Dskip):
        Bsz, L, D = u.shape
        dt = torch.exp(log_dt)[:, None]
        A = A_re + 1j * A_im
        Bc = B_re + 1j * B_im
        Cc = C_re + 1j * C_im
        logdA = dt * A
        dB = dt * Bc
        l = (lambda x, dt: x.to(dt))(torch.arange(L), A_re.dtype)
        P = torch.exp(logdA[:, :, None] * l[None, None, :])
        K = torch.einsum("dn,dnl,dn->dl", Cc, P, dB).real
        L2 = 2 * L
        Kp = _pad(K, ((0, 0), (0, L)))
        up = (lambda x, *d: x.permute(*d))(u, 0, 2, 1)
        up = _pad(up, ((0, 0), (0, 0), (0, L)))
        Kf = (lambda x, axes=(-2,-1): torch.fft.rfft2(x.float(), dim=axes))(Kp[:, None, :], axes=(-2, -1))
        Uf = (lambda x, axes=(-2,-1): torch.fft.rfft2(x.float(), dim=axes))(up[:, :, None, :], axes=(-2, -1))
        Yf = Uf * Kf[None, :, :, :]
        y = (lambda x, s, axes=(-2,-1): torch.fft.irfft2(x, s=s, dim=axes).to(torch.bfloat16))(Yf, (1, L2), axes=(-2, -1))[:, :, 0, :L]
        y = (lambda x, *d: x.permute(*d))(y, 0, 2, 1) + u * Dskip[None, None, :]
        return y

    a = _A_ref(A_x, A_c_kv, A_w_q, A_w_uk, A_w_uv, A_w_o)
    b = _B_ref(B_u, B_A_re, B_A_im, B_B_re, B_B_im, B_C_re, B_C_im, B_log_dt, B_Dskip)
    return torch.concatenate([a, b], axis=-1)
```

```asm
; @launch kernel=k1_proj_kernel grid=(256,1,1) block=(512,1,1) lds=163840
; @launch kernel=k2_attn_kernel grid=(256,1,1) block=(512,1,1) lds=163840
; @launch kernel=k3_out_kernel grid=(512,1,1) block=(512,1,1) lds=78912
.amdgcn_target "amdgcn-amd-amdhsa--gfx950"
.text
.globl k1_proj_kernel
.p2align 8
.type k1_proj_kernel,@function
k1_proj_kernel:
    s_cmp_ge_u32 s2, 256
    s_cbranch_scc1 L_k1_end
    s_load_dwordx4 s[32:35], s[0:1], 0
    s_load_dwordx4 s[36:39], s[0:1], 16
    s_load_dwordx2 s[40:41], s[0:1], 32
    s_load_dwordx2 s[42:43], s[0:1], 136
    s_load_dwordx2 s[52:53], s[0:1], 40
    s_load_dwordx2 s[62:63], s[0:1], 48
    v_lshrrev_b32 v236, 6, v0
    s_nop 0
    v_readfirstlane_b32 s3, v236
    v_and_b32 v236, 63, v0
    s_and_b32 s4, s2, 7
    s_lshl_b32 s4, s4, 2
    s_lshr_b32 s5, s2, 3
    s_and_b32 s5, s5, 3
    s_add_u32 s4, s4, s5
    s_lshr_b32 s5, s2, 5
    v_lshrrev_b32 v237, 3, v236
    v_and_b32 v238, 7, v236
    v_bfe_u32 v239, v236, 4, 1
    v_lshlrev_b32 v239, 2, v239
    v_xor_b32 v239, v238, v239
    v_lshlrev_b32 v239, 4, v239
    v_lshl_add_u32 v225, v237, 13, v239
    v_lshrrev_b32 v239, 1, v237
    v_xor_b32 v239, v238, v239
    v_lshlrev_b32 v239, 4, v239
    v_lshl_add_u32 v224, v237, 10, v239
    v_xor_b32 v240, 64, v224
    v_lshlrev_b32 v228, 4, v236
    v_and_b32 v237, 31, v236
    v_bfe_u32 v238, v236, 1, 3
    v_lshrrev_b32 v239, 5, v236
    v_xor_b32 v238, v238, v239
    v_lshlrev_b32 v238, 4, v238
    v_lshl_add_u32 v237, v237, 7, v238
    s_mul_i32 s50, s3, 12288
    s_add_u32 s50, s50, 65536
    v_xor_b32 v238, 0, v237
    v_add_u32 v229, s50, v238
    v_xor_b32 v238, 32, v237
    v_add_u32 v230, s50, v238
    v_xor_b32 v238, 64, v237
    v_add_u32 v231, s50, v238
    v_xor_b32 v238, 96, v237
    v_add_u32 v232, s50, v238
    v_lshrrev_b32 v237, 5, v236
    v_lshlrev_b32 v237, 10, v237
    v_bfe_u32 v238, v236, 2, 2
    v_lshl_add_u32 v237, v238, 7, v237
    v_bfe_u32 v239, v236, 4, 1
    v_lshl_add_u32 v237, v239, 5, v237
    v_and_b32 v239, 3, v236
    v_lshl_add_u32 v237, v239, 3, v237
    v_bfe_u32 v238, v236, 3, 1
    v_xor_b32 v239, 0, v238
    v_lshl_add_u32 v226, v239, 6, v237
    v_xor_b32 v239, 1, v238
    v_lshl_add_u32 v227, v239, 6, v237
    s_waitcnt lgkmcnt(0)
    s_mov_b32 s8, s32
    s_and_b32 s9, s33, 0xffff
    s_mov_b32 s10, 0x200000
    s_mov_b32 s11, 0x20000
    s_mov_b32 s12, s34
    s_and_b32 s13, s35, 0xffff
    s_mov_b32 s14, 0x200000
    s_mov_b32 s15, 0x20000
    s_mov_b32 s16, s36
    s_and_b32 s17, s37, 0xffff
    s_mov_b32 s18, 0x400000
    s_mov_b32 s19, 0x20000
    s_mov_b32 s20, s38
    s_and_b32 s21, s39, 0xffff
    s_mov_b32 s22, 0x400000
    s_mov_b32 s23, 0x20000
    s_mov_b32 s24, s40
    s_and_b32 s25, s41, 0xffff
    s_mov_b32 s26, 0x400000
    s_mov_b32 s27, 0x20000
    s_mov_b32 s28, s42
    s_and_b32 s29, s43, 0xffff
    s_mov_b32 s30, 0x4800000
    s_mov_b32 s31, 0x20000
    s_mov_b32 s56, s52
    s_and_b32 s57, s53, 0xffff
    s_mov_b32 s58, 0x400000
    s_mov_b32 s59, 0x20000
    s_mov_b32 s60, s62
    s_and_b32 s61, s63, 0xffff
    s_mov_b32 s62, 0x200000
    s_mov_b32 s63, 0x20000
    s_lshl_b32 s6, s5, 3
    s_add_u32 s6, s6, s3
    s_mov_b32 s47, s6
    s_lshl_b32 s6, s6, 15
    s_lshl_b32 s7, s3, 17
    s_lshl_b32 s46, s4, 8
    s_add_u32 s7, s7, s46
    s_lshl_b32 s44, s3, 11
    s_lshl_b32 s45, s4, 6
    s_add_u32 s45, s45, s47
    s_lshl_b32 s45, s45, 13
    s_lshr_b32 s48, s47, 1
    s_lshl_b32 s46, s4, 5
    s_add_u32 s48, s48, s46
    s_lshl_b32 s48, s48, 14
    s_and_b32 s46, s3, 1
    s_lshl_b32 s46, s46, 11
    s_add_u32 s48, s48, s46
    s_add_u32 s48, s48, 0x2000000
    s_mov_b32 s49, 0x3e0293ee
    s_mov_b32 s54, 0x3f800000
    s_add_u32 s46, s7, 0x0
    s_add_u32 m0, s44, 0x0
    s_nop 0
    buffer_load_dwordx4 v225, s[20:23], s46 offen lds
    s_add_u32 s46, s7, 0x10000
    s_add_u32 m0, s44, 0x400
    s_nop 0
    buffer_load_dwordx4 v225, s[20:23], s46 offen lds
    s_add_u32 s46, s6, 0x0
    s_add_u32 m0, s50, 0x0
    s_nop 0
    buffer_load_dwordx4 v224, s[12:15], s46 offen lds
    s_add_u32 s46, s6, 0x2000
    s_add_u32 m0, s50, 0x400
    s_nop 0
    buffer_load_dwordx4 v240, s[12:15], s46 offen lds
    s_add_u32 s46, s6, 0x4000
    s_add_u32 m0, s50, 0x800
    s_nop 0
    buffer_load_dwordx4 v224, s[12:15], s46 offen lds
    s_add_u32 s46, s6, 0x6000
    s_add_u32 m0, s50, 0xc00
    s_nop 0
    buffer_load_dwordx4 v240, s[12:15], s46 offen lds
    s_add_u32 s46, s6, 0x80
    s_add_u32 m0, s50, 0x1000
    s_nop 0
    buffer_load_dwordx4 v224, s[12:15], s46 offen lds
    s_add_u32 s46, s6, 0x2080
    s_add_u32 m0, s50, 0x1400
    s_nop 0
    buffer_load_dwordx4 v240, s[12:15], s46 offen lds
    s_add_u32 s46, s6, 0x4080
    s_add_u32 m0, s50, 0x1800
    s_nop 0
    buffer_load_dwordx4 v224, s[12:15], s46 offen lds
    s_add_u32 s46, s6, 0x6080
    s_add_u32 m0, s50, 0x1c00
    s_nop 0
    buffer_load_dwordx4 v240, s[12:15], s46 offen lds
    s_add_u32 s46, s7, 0x80
    s_add_u32 m0, s44, 0x4000
    s_nop 0
    buffer_load_dwordx4 v225, s[20:23], s46 offen lds
    s_add_u32 s46, s7, 0x10080
    s_add_u32 m0, s44, 0x4400
    s_nop 0
    buffer_load_dwordx4 v225, s[20:23], s46 offen lds
    s_add_u32 s46, s6, 0x100
    s_add_u32 m0, s50, 0x2000
    s_nop 0
    buffer_load_dwordx4 v224, s[12:15], s46 offen lds
    s_add_u32 s46, s6, 0x2100
    s_add_u32 m0, s50, 0x2400
    s_nop 0
    buffer_load_dwordx4 v240, s[12:15], s46 offen lds
    s_add_u32 s46, s6, 0x4100
    s_add_u32 m0, s50, 0x2800
    s_nop 0
    buffer_load_dwordx4 v224, s[12:15], s46 offen lds
    s_add_u32 s46, s6, 0x6100
    s_add_u32 m0, s50, 0x2c00
    s_nop 0
    buffer_load_dwordx4 v240, s[12:15], s46 offen lds
    s_add_u32 s46, s7, 0x100000
    s_add_u32 m0, s44, 0x8000
    s_nop 0
    buffer_load_dwordx4 v225, s[20:23], s46 offen lds
    s_add_u32 s46, s7, 0x110000
    s_add_u32 m0, s44, 0x8400
    s_nop 0
    buffer_load_dwordx4 v225, s[20:23], s46 offen lds
    s_lshl_b32 s55, s2, 3
    s_add_u32 s55, s55, s3
    s_lshl_b32 s66, s55, 10
    s_lshl_b32 s55, s55, 11
    s_waitcnt vmcnt(12)
    ds_read_b128 v[0:3], v229 offset:0
    ds_read_b128 v[4:7], v230 offset:0
    ds_read_b128 v[8:11], v231 offset:0
    ds_read_b128 v[12:15], v232 offset:0
    s_waitcnt lgkmcnt(0)
    s_add_u32 s46, s6, 0x180
    s_add_u32 m0, s50, 0x0
    s_nop 0
    buffer_load_dwordx4 v224, s[12:15], s46 offen lds
    s_add_u32 s46, s6, 0x2180
    s_add_u32 m0, s50, 0x400
    s_nop 0
    buffer_load_dwordx4 v240, s[12:15], s46 offen lds
    s_add_u32 s46, s6, 0x4180
    s_add_u32 m0, s50, 0x800
    s_nop 0
    buffer_load_dwordx4 v224, s[12:15], s46 offen lds
    s_add_u32 s46, s6, 0x6180
    s_add_u32 m0, s50, 0xc00
    s_nop 0
    buffer_load_dwordx4 v240, s[12:15], s46 offen lds
    s_waitcnt vmcnt(12)
    ds_read_b128 v[16:19], v229 offset:4096
    ds_read_b128 v[20:23], v230 offset:4096
    ds_read_b128 v[24:27], v231 offset:4096
    ds_read_b128 v[28:31], v232 offset:4096
    s_waitcnt lgkmcnt(0)
    s_add_u32 s46, s6, 0x200
    s_add_u32 m0, s50, 0x1000
    s_nop 0
    buffer_load_dwordx4 v224, s[12:15], s46 offen lds
    s_add_u32 s46, s6, 0x2200
    s_add_u32 m0, s50, 0x1400
    s_nop 0
    buffer_load_dwordx4 v240, s[12:15], s46 offen lds
    s_add_u32 s46, s6, 0x4200
    s_add_u32 m0, s50, 0x1800
    s_nop 0
    buffer_load_dwordx4 v224, s[12:15], s46 offen lds
    s_add_u32 s46, s6, 0x6200
    s_add_u32 m0, s50, 0x1c00
    s_nop 0
    buffer_load_dwordx4 v240, s[12:15], s46 offen lds
    s_waitcnt vmcnt(14)
    s_barrier
    s_add_u32 s46, s7, 0x100080
    s_add_u32 m0, s44, 0xc000
    s_nop 0
    buffer_load_dwordx4 v225, s[20:23], s46 offen lds
    s_add_u32 s46, s7, 0x110080
    s_add_u32 m0, s44, 0xc400
    s_nop 0
    buffer_load_dwordx4 v225, s[20:23], s46 offen lds
    ds_read_b64_tr_b16 v[192:193], v226 offset:0
    ds_read_b64_tr_b16 v[194:195], v226 offset:512
    ds_read_b64_tr_b16 v[196:197], v226 offset:2048
    ds_read_b64_tr_b16 v[198:199], v226 offset:2560
    ds_read_b64_tr_b16 v[200:201], v226 offset:4096
    ds_read_b64_tr_b16 v[202:203], v226 offset:4608
    ds_read_b64_tr_b16 v[204:205], v226 offset:6144
    ds_read_b64_tr_b16 v[206:207], v226 offset:6656
    ds_read_b64_tr_b16 v[208:209], v226 offset:8192
    ds_read_b64_tr_b16 v[210:211], v226 offset:8704
    ds_read_b64_tr_b16 v[212:213], v226 offset:10240
    ds_read_b64_tr_b16 v[214:215], v226 offset:10752
    ds_read_b64_tr_b16 v[216:217], v226 offset:12288
    ds_read_b64_tr_b16 v[218:219], v226 offset:12800
    s_waitcnt lgkmcnt(12)
    v_mfma_f32_32x32x16_bf16 v[128:143], v[192:195], v[0:3], 0
    ds_read_b64_tr_b16 v[220:221], v226 offset:14336
    ds_read_b64_tr_b16 v[222:223], v226 offset:14848
    s_waitcnt lgkmcnt(12)
    v_mfma_f32_32x32x16_bf16 v[128:143], v[196:199], v[4:7], v[128:143]
    ds_read_b64_tr_b16 v[192:193], v227 offset:0
    ds_read_b64_tr_b16 v[194:195], v227 offset:512
    s_waitcnt lgkmcnt(12)
    v_mfma_f32_32x32x16_bf16 v[128:143], v[200:203], v[8:11], v[128:143]
    ds_read_b64_tr_b16 v[196:197], v227 offset:2048
    ds_read_b64_tr_b16 v[198:199], v227 offset:2560
    s_waitcnt lgkmcnt(12)
    v_mfma_f32_32x32x16_bf16 v[128:143], v[204:207], v[12:15], v[128:143]
    ds_read_b64_tr_b16 v[200:201], v227 offset:4096
    ds_read_b64_tr_b16 v[202:203], v227 offset:4608
    s_waitcnt lgkmcnt(12)
    v_mfma_f32_32x32x16_bf16 v[128:143], v[208:211], v[16:19], v[128:143]
    ds_read_b64_tr_b16 v[204:205], v227 offset:6144
    ds_read_b64_tr_b16 v[206:207], v227 offset:6656
    s_waitcnt lgkmcnt(12)
    v_mfma_f32_32x32x16_bf16 v[128:143], v[212:215], v[20:23], v[128:143]
    ds_read_b64_tr_b16 v[208:209], v227 offset:8192
    ds_read_b64_tr_b16 v[210:211], v227 offset:8704
    s_waitcnt lgkmcnt(12)
    v_mfma_f32_32x32x16_bf16 v[128:143], v[216:219], v[24:27], v[128:143]
    ds_read_b64_tr_b16 v[212:213], v227 offset:10240
    ds_read_b64_tr_b16 v[214:215], v227 offset:10752
    s_waitcnt lgkmcnt(12)
    v_mfma_f32_32x32x16_bf16 v[128:143], v[220:223], v[28:31], v[128:143]
    ds_read_b64_tr_b16 v[216:217], v227 offset:12288
    ds_read_b64_tr_b16 v[218:219], v227 offset:12800
    s_waitcnt lgkmcnt(12)
    v_mfma_f32_32x32x16_bf16 v[144:159], v[192:195], v[0:3], 0
    ds_read_b64_tr_b16 v[220:221], v227 offset:14336
    ds_read_b64_tr_b16 v[222:223], v227 offset:14848
    s_waitcnt lgkmcnt(12)
    v_mfma_f32_32x32x16_bf16 v[144:159], v[196:199], v[4:7], v[144:159]
    ds_read_b64_tr_b16 v[192:193], v226 offset:16384
    ds_read_b64_tr_b16 v[194:195], v226 offset:16896
    s_waitcnt lgkmcnt(12)
    v_mfma_f32_32x32x16_bf16 v[144:159], v[200:203], v[8:11], v[144:159]
    ds_read_b64_tr_b16 v[196:197], v226 offset:18432
    ds_read_b64_tr_b16 v[198:199], v226 offset:18944
    s_waitcnt lgkmcnt(12)
    v_mfma_f32_32x32x16_bf16 v[144:159], v[204:207], v[12:15], v[144:159]
    ds_read_b64_tr_b16 v[200:201], v226 offset:20480
    ds_read_b64_tr_b16 v[202:203], v226 offset:20992
    s_waitcnt lgkmcnt(12)
    v_mfma_f32_32x32x16_bf16 v[144:159], v[208:211], v[16:19], v[144:159]
    ds_read_b64_tr_b16 v[204:205], v226 offset:22528
    ds_read_b64_tr_b16 v[206:207], v226 offset:23040
    s_waitcnt lgkmcnt(12)
    v_mfma_f32_32x32x16_bf16 v[144:159], v[212:215], v[20:23], v[144:159]
    ds_read_b64_tr_b16 v[208:209], v226 offset:24576
    ds_read_b64_tr_b16 v[210:211], v226 offset:25088
    s_waitcnt lgkmcnt(12)
    v_mfma_f32_32x32x16_bf16 v[144:159], v[216:219], v[24:27], v[144:159]
    ds_read_b64_tr_b16 v[212:213], v226 offset:26624
    ds_read_b64_tr_b16 v[214:215], v226 offset:27136
    s_waitcnt lgkmcnt(12)
    v_mfma_f32_32x32x16_bf16 v[144:159], v[220:223], v[28:31], v[144:159]
    s_waitcnt vmcnt(12)
    ds_read_b128 v[32:35], v229 offset:8192
    ds_read_b128 v[36:39], v230 offset:8192
    ds_read_b128 v[40:43], v231 offset:8192
    ds_read_b128 v[44:47], v232 offset:8192
    s_waitcnt lgkmcnt(0)
    s_add_u32 s46, s6, 0x280
    s_add_u32 m0, s50, 0x2000
    s_nop 0
    buffer_load_dwordx4 v224, s[12:15], s46 offen lds
    s_add_u32 s46, s6, 0x2280
    s_add_u32 m0, s50, 0x2400
    s_nop 0
    buffer_load_dwordx4 v240, s[12:15], s46 offen lds
    s_add_u32 s46, s6, 0x4280
    s_add_u32 m0, s50, 0x2800
    s_nop 0
    buffer_load_dwordx4 v224, s[12:15], s46 offen lds
    s_add_u32 s46, s6, 0x6280
    s_add_u32 m0, s50, 0x2c00
    s_nop 0
    buffer_load_dwordx4 v240, s[12:15], s46 offen lds
    s_waitcnt vmcnt(14)
    s_barrier
    s_add_u32 s46, s7, 0x200000
    s_add_u32 m0, s44, 0x0
    s_nop 0
    buffer_load_dwordx4 v225, s[20:23], s46 offen lds
    s_add_u32 s46, s7, 0x210000
    s_add_u32 m0, s44, 0x400
    s_nop 0
    buffer_load_dwordx4 v225, s[20:23], s46 offen lds
    ds_read_b64_tr_b16 v[216:217], v226 offset:28672
    ds_read_b64_tr_b16 v[218:219], v226 offset:29184
    v_mfma_f32_32x32x16_bf16 v[160:175], v[192:195], v[0:3], 0
    ds_read_b64_tr_b16 v[220:221], v226 offset:30720
    ds_read_b64_tr_b16 v[222:223], v226 offset:31232
    v_mfma_f32_32x32x16_bf16 v[160:175], v[196:199], v[4:7], v[160:175]
    ds_read_b64_tr_b16 v[192:193], v227 offset:16384
    ds_read_b64_tr_b16 v[194:195], v227 offset:16896
    v_mfma_f32_32x32x16_bf16 v[160:175], v[200:203], v[8:11], v[160:175]
    ds_read_b64_tr_b16 v[196:197], v227 offset:18432
    ds_read_b64_tr_b16 v[198:199], v227 offset:18944
    v_mfma_f32_32x32x16_bf16 v[160:175], v[204:207], v[12:15], v[160:175]
    ds_read_b64_tr_b16 v[200:201], v227 offset:20480
    ds_read_b64_tr_b16 v[202:203], v227 offset:20992
    v_mfma_f32_32x32x16_bf16 v[160:175], v[208:211], v[16:19], v[160:175]
    ds_read_b64_tr_b16 v[204:205], v227 offset:22528
    ds_read_b64_tr_b16 v[206:207], v227 offset:23040
    v_mfma_f32_32x32x16_bf16 v[160:175], v[212:215], v[20:23], v[160:175]
    ds_read_b64_tr_b16 v[208:209], v227 offset:24576
    ds_read_b64_tr_b16 v[210:211], v227 offset:25088
    s_waitcnt lgkmcnt(12)
    v_mfma_f32_32x32x16_bf16 v[160:175], v[216:219], v[24:27], v[160:175]
    ds_read_b64_tr_b16 v[212:213], v227 offset:26624
    ds_read_b64_tr_b16 v[214:215], v227 offset:27136
    s_waitcnt lgkmcnt(12)
    v_mfma_f32_32x32x16_bf16 v[160:175], v[220:223], v[28:31], v[160:175]
    ds_read_b64_tr_b16 v[216:217], v227 offset:28672
    ds_read_b64_tr_b16 v[218:219], v227 offset:29184
    s_waitcnt lgkmcnt(12)
    v_mfma_f32_32x32x16_bf16 v[176:191], v[192:195], v[0:3], 0
    ds_read_b64_tr_b16 v[220:221], v227 offset:30720
    ds_read_b64_tr_b16 v[222:223], v227 offset:31232
    s_waitcnt lgkmcnt(12)
    v_mfma_f32_32x32x16_bf16 v[176:191], v[196:199], v[4:7], v[176:191]
    ds_read_b64_tr_b16 v[192:193], v226 offset:32768
    ds_read_b64_tr_b16 v[194:195], v226 offset:33280
    s_waitcnt lgkmcnt(12)
    v_mfma_f32_32x32x16_bf16 v[176:191], v[200:203], v[8:11], v[176:191]
    ds_read_b64_tr_b16 v[196:197], v226 offset:34816
    ds_read_b64_tr_b16 v[198:199], v226 offset:35328
    s_waitcnt lgkmcnt(12)
    v_mfma_f32_32x32x16_bf16 v[176:191], v[204:207], v[12:15], v[176:191]
    ds_read_b64_tr_b16 v[200:201], v226 offset:36864
    ds_read_b64_tr_b16 v[202:203], v226 offset:37376
    s_waitcnt lgkmcnt(12)
    v_mfma_f32_32x32x16_bf16 v[176:191], v[208:211], v[16:19], v[176:191]
    ds_read_b64_tr_b16 v[204:205], v226 offset:38912
    ds_read_b64_tr_b16 v[206:207], v226 offset:39424
    s_waitcnt lgkmcnt(12)
    v_mfma_f32_32x32x16_bf16 v[176:191], v[212:215], v[20:23], v[176:191]
    ds_read_b64_tr_b16 v[208:209], v226 offset:40960
    ds_read_b64_tr_b16 v[210:211], v226 offset:41472
    s_waitcnt lgkmcnt(12)
    v_mfma_f32_32x32x16_bf16 v[176:191], v[216:219], v[24:27], v[176:191]
    ds_read_b64_tr_b16 v[212:213], v226 offset:43008
    ds_read_b64_tr_b16 v[214:215], v226 offset:43520
    s_waitcnt lgkmcnt(12)
    v_mfma_f32_32x32x16_bf16 v[176:191], v[220:223], v[28:31], v[176:191]
    s_waitcnt vmcnt(12)
    ds_read_b128 v[48:51], v229 offset:0
    ds_read_b128 v[52:55], v230 offset:0
    ds_read_b128 v[56:59], v231 offset:0
    ds_read_b128 v[60:63], v232 offset:0
    s_waitcnt lgkmcnt(0)
    s_add_u32 s46, s6, 0x300
    s_add_u32 m0, s50, 0x0
    s_nop 0
    buffer_load_dwordx4 v224, s[12:15], s46 offen lds
    s_add_u32 s46, s6, 0x2300
    s_add_u32 m0, s50, 0x400
    s_nop 0
    buffer_load_dwordx4 v240, s[12:15], s46 offen lds
    s_add_u32 s46, s6, 0x4300
    s_add_u32 m0, s50, 0x800
    s_nop 0
    buffer_load_dwordx4 v224, s[12:15], s46 offen lds
    s_add_u32 s46, s6, 0x6300
    s_add_u32 m0, s50, 0xc00
    s_nop 0
    buffer_load_dwordx4 v240, s[12:15], s46 offen lds
    s_waitcnt vmcnt(10)
    s_barrier
    s_add_u32 s46, s7, 0x200080
    s_add_u32 m0, s44, 0x4000
    s_nop 0
    buffer_load_dwordx4 v225, s[20:23], s46 offen lds
    s_add_u32 s46, s7, 0x210080
    s_add_u32 m0, s44, 0x4400
    s_nop 0
    buffer_load_dwordx4 v225, s[20:23], s46 offen lds
    buffer_load_dwordx4 v[252:255], v228, s[24:27], s55 offen offset:0
    ds_read_b64_tr_b16 v[216:217], v226 offset:45056
    ds_read_b64_tr_b16 v[218:219], v226 offset:45568
    v_mfma_f32_32x32x16_bf16 v[128:143], v[192:195], v[32:35], v[128:143]
    ds_read_b64_tr_b16 v[220:221], v226 offset:47104
    ds_read_b64_tr_b16 v[222:223], v226 offset:47616
    v_mfma_f32_32x32x16_bf16 v[128:143], v[196:199], v[36:39], v[128:143]
    ds_read_b64_tr_b16 v[192:193], v227 offset:32768
    ds_read_b64_tr_b16 v[194:195], v227 offset:33280
    v_mfma_f32_32x32x16_bf16 v[128:143], v[200:203], v[40:43], v[128:143]
    ds_read_b64_tr_b16 v[196:197], v227 offset:34816
    ds_read_b64_tr_b16 v[198:199], v227 offset:35328
    v_mfma_f32_32x32x16_bf16 v[128:143], v[204:207], v[44:47], v[128:143]
    ds_read_b64_tr_b16 v[200:201], v227 offset:36864
    ds_read_b64_tr_b16 v[202:203], v227 offset:37376
    v_mfma_f32_32x32x16_bf16 v[128:143], v[208:211], v[48:51], v[128:143]
    ds_read_b64_tr_b16 v[204:205], v227 offset:38912
    ds_read_b64_tr_b16 v[206:207], v227 offset:39424
    v_mfma_f32_32x32x16_bf16 v[128:143], v[212:215], v[52:55], v[128:143]
    ds_read_b64_tr_b16 v[208:209], v227 offset:40960
    ds_read_b64_tr_b16 v[210:211], v227 offset:41472
    s_waitcnt lgkmcnt(12)
    v_mfma_f32_32x32x16_bf16 v[128:143], v[216:219], v[56:59], v[128:143]
    ds_read_b64_tr_b16 v[212:213], v227 offset:43008
    ds_read_b64_tr_b16 v[214:215], v227 offset:43520
    s_waitcnt lgkmcnt(12)
    v_mfma_f32_32x32x16_bf16 v[128:143], v[220:223], v[60:63], v[128:143]
    ds_read_b64_tr_b16 v[216:217], v227 offset:45056
    ds_read_b64_tr_b16 v[218:219], v227 offset:45568
    s_waitcnt lgkmcnt(12)
    v_mfma_f32_32x32x16_bf16 v[144:159], v[192:195], v[32:35], v[144:159]
    ds_read_b64_tr_b16 v[220:221], v227 offset:47104
    ds_read_b64_tr_b16 v[222:223], v227 offset:47616
    s_waitcnt lgkmcnt(12)
    v_mfma_f32_32x32x16_bf16 v[144:159], v[196:199], v[36:39], v[144:159]
    ds_read_b64_tr_b16 v[192:193], v226 offset:49152
    ds_read_b64_tr_b16 v[194:195], v226 offset:49664
    s_waitcnt lgkmcnt(12)
    v_mfma_f32_32x32x16_bf16 v[144:159], v[200:203], v[40:43], v[144:159]
    ds_read_b64_tr_b16 v[196:197], v226 offset:51200
    ds_read_b64_tr_b16 v[198:199], v226 offset:51712
    s_waitcnt lgkmcnt(12)
    v_mfma_f32_32x32x16_bf16 v[144:159], v[204:207], v[44:47], v[144:159]
    ds_read_b64_tr_b16 v[200:201], v226 offset:53248
    ds_read_b64_tr_b16 v[202:203], v226 offset:53760
    s_waitcnt lgkmcnt(12)
    v_mfma_f32_32x32x16_bf16 v[144:159], v[208:211], v[48:51], v[144:159]
    ds_read_b64_tr_b16 v[204:205], v226 offset:55296
    ds_read_b64_tr_b16 v[206:207], v226 offset:55808
    s_waitcnt lgkmcnt(12)
    v_mfma_f32_32x32x16_bf16 v[144:159], v[212:215], v[52:55], v[144:159]
    ds_read_b64_tr_b16 v[208:209], v226 offset:57344
    ds_read_b64_tr_b16 v[210:211], v226 offset:57856
    s_waitcnt lgkmcnt(12)
    v_mfma_f32_32x32x16_bf16 v[144:159], v[216:219], v[56:59], v[144:159]
    ds_read_b64_tr_b16 v[212:213], v226 offset:59392
    ds_read_b64_tr_b16 v[214:215], v226 offset:59904
    s_waitcnt lgkmcnt(12)
    v_mfma_f32_32x32x16_bf16 v[144:159], v[220:223], v[60:63], v[144:159]
    ds_read_b128 v[64:67], v229 offset:4096
    ds_read_b128 v[68:71], v230 offset:4096
    ds_read_b128 v[72:75], v231 offset:4096
    ds_read_b128 v[76:79], v232 offset:4096
    s_waitcnt lgkmcnt(0)
    s_add_u32 s46, s6, 0x380
    s_add_u32 m0, s50, 0x1000
    s_nop 0
    buffer_load_dwordx4 v224, s[12:15], s46 offen lds
    s_add_u32 s46, s6, 0x2380
    s_add_u32 m0, s50, 0x1400
    s_nop 0
    buffer_load_dwordx4 v240, s[12:15], s46 offen lds
    s_add_u32 s46, s6, 0x4380
    s_add_u32 m0, s50, 0x1800
    s_nop 0
    buffer_load_dwordx4 v224, s[12:15], s46 offen lds
    s_add_u32 s46, s6, 0x6380
    s_add_u32 m0, s50, 0x1c00
    s_nop 0
    buffer_load_dwordx4 v240, s[12:15], s46 offen lds
    s_waitcnt vmcnt(11)
    s_barrier
    s_add_u32 s46, s7, 0x300000
    s_add_u32 m0, s44, 0x8000
    s_nop 0
    buffer_load_dwordx4 v225, s[20:23], s46 offen lds
    s_add_u32 s46, s7, 0x310000
    s_add_u32 m0, s44, 0x8400
    s_nop 0
    buffer_load_dwordx4 v225, s[20:23], s46 offen lds
    buffer_load_dwordx4 v[252:255], v228, s[24:27], s55 offen offset:1024
    ds_read_b64_tr_b16 v[216:217], v226 offset:61440
    ds_read_b64_tr_b16 v[218:219], v226 offset:61952
    v_mfma_f32_32x32x16_bf16 v[160:175], v[192:195], v[32:35], v[160:175]
    ds_read_b64_tr_b16 v[220:221], v226 offset:63488
    ds_read_b64_tr_b16 v[222:223], v226 offset:64000
    v_mfma_f32_32x32x16_bf16 v[160:175], v[196:199], v[36:39], v[160:175]
    ds_read_b64_tr_b16 v[192:193], v227 offset:49152
    ds_read_b64_tr_b16 v[194:195], v227 offset:49664
    v_mfma_f32_32x32x16_bf16 v[160:175], v[200:203], v[40:43], v[160:175]
    ds_read_b64_tr_b16 v[196:197], v227 offset:51200
    ds_read_b64_tr_b16 v[198:199], v227 offset:51712
    v_mfma_f32_32x32x16_bf16 v[160:175], v[204:207], v[44:47], v[160:175]
    ds_read_b64_tr_b16 v[200:201], v227 offset:53248
    ds_read_b64_tr_b16 v[202:203], v227 offset:53760
    v_mfma_f32_32x32x16_bf16 v[160:175], v[208:211], v[48:51], v[160:175]
    ds_read_b64_tr_b16 v[204:205], v227 offset:55296
    ds_read_b64_tr_b16 v[206:207], v227 offset:55808
    v_mfma_f32_32x32x16_bf16 v[160:175], v[212:215], v[52:55], v[160:175]
    ds_read_b64_tr_b16 v[208:209], v227 offset:57344
    ds_read_b64_tr_b16 v[210:211], v227 offset:57856
    s_waitcnt lgkmcnt(12)
    v_mfma_f32_32x32x16_bf16 v[160:175], v[216:219], v[56:59], v[160:175]
    ds_read_b64_tr_b16 v[212:213], v227 offset:59392
    ds_read_b64_tr_b16 v[214:215], v227 offset:59904
    s_waitcnt lgkmcnt(12)
    v_mfma_f32_32x32x16_bf16 v[160:175], v[220:223], v[60:63], v[160:175]
    ds_read_b64_tr_b16 v[216:217], v227 offset:61440
    ds_read_b64_tr_b16 v[218:219], v227 offset:61952
    s_waitcnt lgkmcnt(12)
    v_mfma_f32_32x32x16_bf16 v[176:191], v[192:195], v[32:35], v[176:191]
    ds_read_b64_tr_b16 v[220:221], v227 offset:63488
    ds_read_b64_tr_b16 v[222:223], v227 offset:64000
    s_waitcnt lgkmcnt(12)
    v_mfma_f32_32x32x16_bf16 v[176:191], v[196:199], v[36:39], v[176:191]
    ds_read_b64_tr_b16 v[192:193], v226 offset:0
    ds_read_b64_tr_b16 v[194:195], v226 offset:512
    s_waitcnt lgkmcnt(12)
    v_mfma_f32_32x32x16_bf16 v[176:191], v[200:203], v[40:43], v[176:191]
    ds_read_b64_tr_b16 v[196:197], v226 offset:2048
    ds_read_b64_tr_b16 v[198:199], v226 offset:2560
    s_waitcnt lgkmcnt(12)
    v_mfma_f32_32x32x16_bf16 v[176:191], v[204:207], v[44:47], v[176:191]
    ds_read_b64_tr_b16 v[200:201], v226 offset:4096
    ds_read_b64_tr_b16 v[202:203], v226 offset:4608
    s_waitcnt lgkmcnt(12)
    v_mfma_f32_32x32x16_bf16 v[176:191], v[208:211], v[48:51], v[176:191]
    ds_read_b64_tr_b16 v[204:205], v226 offset:6144
    ds_read_b64_tr_b16 v[206:207], v226 offset:6656
    s_waitcnt lgkmcnt(12)
    v_mfma_f32_32x32x16_bf16 v[176:191], v[212:215], v[52:55], v[176:191]
    ds_read_b64_tr_b16 v[208:209], v226 offset:8192
    ds_read_b64_tr_b16 v[210:211], v226 offset:8704
    s_waitcnt lgkmcnt(12)
    v_mfma_f32_32x32x16_bf16 v[176:191], v[216:219], v[56:59], v[176:191]
    ds_read_b64_tr_b16 v[212:213], v226 offset:10240
    ds_read_b64_tr_b16 v[214:215], v226 offset:10752
    s_waitcnt lgkmcnt(12)
    v_mfma_f32_32x32x16_bf16 v[176:191], v[220:223], v[60:63], v[176:191]
    ds_read_b128 v[80:83], v229 offset:8192
    ds_read_b128 v[84:87], v230 offset:8192
    ds_read_b128 v[88:91], v231 offset:8192
    ds_read_b128 v[92:95], v232 offset:8192
    s_waitcnt lgkmcnt(0)
    s_add_u32 s46, s6, 0x0
    s_add_u32 m0, s50, 0x2000
    s_nop 0
    buffer_load_dwordx4 v224, s[8:11], s46 offen lds
    s_add_u32 s46, s6, 0x2000
    s_add_u32 m0, s50, 0x2400
    s_nop 0
    buffer_load_dwordx4 v240, s[8:11], s46 offen lds
    s_add_u32 s46, s6, 0x4000
    s_add_u32 m0, s50, 0x2800
    s_nop 0
    buffer_load_dwordx4 v224, s[8:11], s46 offen lds
    s_add_u32 s46, s6, 0x6000
    s_add_u32 m0, s50, 0x2c00
    s_nop 0
    buffer_load_dwordx4 v240, s[8:11], s46 offen lds
    s_waitcnt vmcnt(12)
    s_barrier
    s_add_u32 s46, s7, 0x300080
    s_add_u32 m0, s44, 0xc000
    s_nop 0
    buffer_load_dwordx4 v225, s[20:23], s46 offen lds
    s_add_u32 s46, s7, 0x310080
    s_add_u32 m0, s44, 0xc400
    s_nop 0
    buffer_load_dwordx4 v225, s[20:23], s46 offen lds
    buffer_load_dwordx4 v[252:255], v228, s[8:11], s66 offen
    ds_read_b64_tr_b16 v[216:217], v226 offset:12288
    ds_read_b64_tr_b16 v[218:219], v226 offset:12800
    v_mfma_f32_32x32x16_bf16 v[128:143], v[192:195], v[64:67], v[128:143]
    ds_read_b64_tr_b16 v[220:221], v226 offset:14336
    ds_read_b64_tr_b16 v[222:223], v226 offset:14848
    v_mfma_f32_32x32x16_bf16 v[128:143], v[196:199], v[68:71], v[128:143]
    ds_read_b64_tr_b16 v[192:193], v227 offset:0
    ds_read_b64_tr_b16 v[194:195], v227 offset:512
    v_mfma_f32_32x32x16_bf16 v[128:143], v[200:203], v[72:75], v[128:143]
    ds_read_b64_tr_b16 v[196:197], v227 offset:2048
    ds_read_b64_tr_b16 v[198:199], v227 offset:2560
    v_mfma_f32_32x32x16_bf16 v[128:143], v[204:207], v[76:79], v[128:143]
    ds_read_b64_tr_b16 v[200:201], v227 offset:4096
    ds_read_b64_tr_b16 v[202:203], v227 offset:4608
    v_mfma_f32_32x32x16_bf16 v[128:143], v[208:211], v[80:83], v[128:143]
    ds_read_b64_tr_b16 v[204:205], v227 offset:6144
    ds_read_b64_tr_b16 v[206:207], v227 offset:6656
    v_mfma_f32_32x32x16_bf16 v[128:143], v[212:215], v[84:87], v[128:143]
    ds_read_b64_tr_b16 v[208:209], v227 offset:8192
    ds_read_b64_tr_b16 v[210:211], v227 offset:8704
    s_waitcnt lgkmcnt(12)
    v_mfma_f32_32x32x16_bf16 v[128:143], v[216:219], v[88:91], v[128:143]
    ds_read_b64_tr_b16 v[212:213], v227 offset:10240
    ds_read_b64_tr_b16 v[214:215], v227 offset:10752
    s_waitcnt lgkmcnt(12)
    v_mfma_f32_32x32x16_bf16 v[128:143], v[220:223], v[92:95], v[128:143]
    ds_read_b64_tr_b16 v[216:217], v227 offset:12288
    ds_read_b64_tr_b16 v[218:219], v227 offset:12800
    s_waitcnt lgkmcnt(12)
    v_mfma_f32_32x32x16_bf16 v[144:159], v[192:195], v[64:67], v[144:159]
    ds_read_b64_tr_b16 v[220:221], v227 offset:14336
    ds_read_b64_tr_b16 v[222:223], v227 offset:14848
    s_waitcnt lgkmcnt(12)
    v_mfma_f32_32x32x16_bf16 v[144:159], v[196:199], v[68:71], v[144:159]
    ds_read_b64_tr_b16 v[192:193], v226 offset:16384
    ds_read_b64_tr_b16 v[194:195], v226 offset:16896
    s_waitcnt lgkmcnt(12)
    v_mfma_f32_32x32x16_bf16 v[144:159], v[200:203], v[72:75], v[144:159]
    ds_read_b64_tr_b16 v[196:197], v226 offset:18432
    ds_read_b64_tr_b16 v[198:199], v226 offset:18944
    s_waitcnt lgkmcnt(12)
    v_mfma_f32_32x32x16_bf16 v[144:159], v[204:207], v[76:79], v[144:159]
    ds_read_b64_tr_b16 v[200:201], v226 offset:20480
    ds_read_b64_tr_b16 v[202:203], v226 offset:20992
    s_waitcnt lgkmcnt(12)
    v_mfma_f32_32x32x16_bf16 v[144:159], v[208:211], v[80:83], v[144:159]
    ds_read_b64_tr_b16 v[204:205], v226 offset:22528
    ds_read_b64_tr_b16 v[206:207], v226 offset:23040
    s_waitcnt lgkmcnt(12)
    v_mfma_f32_32x32x16_bf16 v[144:159], v[212:215], v[84:87], v[144:159]
    ds_read_b64_tr_b16 v[208:209], v226 offset:24576
    ds_read_b64_tr_b16 v[210:211], v226 offset:25088
    s_waitcnt lgkmcnt(12)
    v_mfma_f32_32x32x16_bf16 v[144:159], v[216:219], v[88:91], v[144:159]
    ds_read_b64_tr_b16 v[212:213], v226 offset:26624
    ds_read_b64_tr_b16 v[214:215], v226 offset:27136
    s_waitcnt lgkmcnt(12)
    v_mfma_f32_32x32x16_bf16 v[144:159], v[220:223], v[92:95], v[144:159]
    ds_read_b128 v[96:99], v229 offset:0
    ds_read_b128 v[100:103], v230 offset:0
    ds_read_b128 v[104:107], v231 offset:0
    ds_read_b128 v[108:111], v232 offset:0
    s_waitcnt lgkmcnt(0)
    s_add_u32 s46, s6, 0x80
    s_add_u32 m0, s50, 0x0
    s_nop 0
    buffer_load_dwordx4 v224, s[8:11], s46 offen lds
    s_add_u32 s46, s6, 0x2080
    s_add_u32 m0, s50, 0x400
    s_nop 0
    buffer_load_dwordx4 v240, s[8:11], s46 offen lds
    s_add_u32 s46, s6, 0x4080
    s_add_u32 m0, s50, 0x800
    s_nop 0
    buffer_load_dwordx4 v224, s[8:11], s46 offen lds
    s_add_u32 s46, s6, 0x6080
    s_add_u32 m0, s50, 0xc00
    s_nop 0
    buffer_load_dwordx4 v240, s[8:11], s46 offen lds
    s_waitcnt vmcnt(12)
    s_barrier
    s_add_u32 s46, s7, 0x0
    s_add_u32 m0, s44, 0x0
    s_nop 0
    buffer_load_dwordx4 v225, s[24:27], s46 offen lds
    s_add_u32 s46, s7, 0x10000
    s_add_u32 m0, s44, 0x400
    s_nop 0
    buffer_load_dwordx4 v225, s[24:27], s46 offen lds
    buffer_load_dwordx4 v[252:255], v228, s[16:19], s55 offen offset:0
    ds_read_b64_tr_b16 v[216:217], v226 offset:28672
    ds_read_b64_tr_b16 v[218:219], v226 offset:29184
    v_mfma_f32_32x32x16_bf16 v[160:175], v[192:195], v[64:67], v[160:175]
    ds_read_b64_tr_b16 v[220:221], v226 offset:30720
    ds_read_b64_tr_b16 v[222:223], v226 offset:31232
    v_mfma_f32_32x32x16_bf16 v[160:175], v[196:199], v[68:71], v[160:175]
    ds_read_b64_tr_b16 v[192:193], v227 offset:16384
    ds_read_b64_tr_b16 v[194:195], v227 offset:16896
    v_mfma_f32_32x32x16_bf16 v[160:175], v[200:203], v[72:75], v[160:175]
    ds_read_b64_tr_b16 v[196:197], v227 offset:18432
    ds_read_b64_tr_b16 v[198:199], v227 offset:18944
    v_mfma_f32_32x32x16_bf16 v[160:175], v[204:207], v[76:79], v[160:175]
    ds_read_b64_tr_b16 v[200:201], v227 offset:20480
    ds_read_b64_tr_b16 v[202:203], v227 offset:20992
    v_mfma_f32_32x32x16_bf16 v[160:175], v[208:211], v[80:83], v[160:175]
    ds_read_b64_tr_b16 v[204:205], v227 offset:22528
    ds_read_b64_tr_b16 v[206:207], v227 offset:23040
    v_mfma_f32_32x32x16_bf16 v[160:175], v[212:215], v[84:87], v[160:175]
    ds_read_b64_tr_b16 v[208:209], v227 offset:24576
    ds_read_b64_tr_b16 v[210:211], v227 offset:25088
    s_waitcnt lgkmcnt(12)
    v_mfma_f32_32x32x16_bf16 v[160:175], v[216:219], v[88:91], v[160:175]
    ds_read_b64_tr_b16 v[212:213], v227 offset:26624
    ds_read_b64_tr_b16 v[214:215], v227 offset:27136
    s_waitcnt lgkmcnt(12)
    v_mfma_f32_32x32x16_bf16 v[160:175], v[220:223], v[92:95], v[160:175]
    ds_read_b64_tr_b16 v[216:217], v227 offset:28672
    ds_read_b64_tr_b16 v[218:219], v227 offset:29184
    s_waitcnt lgkmcnt(12)
    v_mfma_f32_32x32x16_bf16 v[176:191], v[192:195], v[64:67], v[176:191]
    ds_read_b64_tr_b16 v[220:221], v227 offset:30720
    ds_read_b64_tr_b16 v[222:223], v227 offset:31232
    s_waitcnt lgkmcnt(12)
    v_mfma_f32_32x32x16_bf16 v[176:191], v[196:199], v[68:71], v[176:191]
    ds_read_b64_tr_b16 v[192:193], v226 offset:32768
    ds_read_b64_tr_b16 v[194:195], v226 offset:33280
    s_waitcnt lgkmcnt(12)
    v_mfma_f32_32x32x16_bf16 v[176:191], v[200:203], v[72:75], v[176:191]
    ds_read_b64_tr_b16 v[196:197], v226 offset:34816
    ds_read_b64_tr_b16 v[198:199], v226 offset:35328
    s_waitcnt lgkmcnt(12)
    v_mfma_f32_32x32x16_bf16 v[176:191], v[204:207], v[76:79], v[176:191]
    ds_read_b64_tr_b16 v[200:201], v226 offset:36864
    ds_read_b64_tr_b16 v[202:203], v226 offset:37376
    s_waitcnt lgkmcnt(12)
    v_mfma_f32_32x32x16_bf16 v[176:191], v[208:211], v[80:83], v[176:191]
    ds_read_b64_tr_b16 v[204:205], v226 offset:38912
    ds_read_b64_tr_b16 v[206:207], v226 offset:39424
    s_waitcnt lgkmcnt(12)
    v_mfma_f32_32x32x16_bf16 v[176:191], v[212:215], v[84:87], v[176:191]
    ds_read_b64_tr_b16 v[208:209], v226 offset:40960
    ds_read_b64_tr_b16 v[210:211], v226 offset:41472
    s_waitcnt lgkmcnt(12)
    v_mfma_f32_32x32x16_bf16 v[176:191], v[216:219], v[88:91], v[176:191]
    ds_read_b64_tr_b16 v[212:213], v226 offset:43008
    ds_read_b64_tr_b16 v[214:215], v226 offset:43520
    s_waitcnt lgkmcnt(12)
    v_mfma_f32_32x32x16_bf16 v[176:191], v[220:223], v[92:95], v[176:191]
    ds_read_b128 v[112:115], v229 offset:4096
    ds_read_b128 v[116:119], v230 offset:4096
    ds_read_b128 v[120:123], v231 offset:4096
    ds_read_b128 v[124:127], v232 offset:4096
    s_waitcnt lgkmcnt(0)
    s_add_u32 s46, s6, 0x100
    s_add_u32 m0, s50, 0x1000
    s_nop 0
    buffer_load_dwordx4 v224, s[8:11], s46 offen lds
    s_add_u32 s46, s6, 0x2100
    s_add_u32 m0, s50, 0x1400
    s_nop 0
    buffer_load_dwordx4 v240, s[8:11], s46 offen lds
    s_add_u32 s46, s6, 0x4100
    s_add_u32 m0, s50, 0x1800
    s_nop 0
    buffer_load_dwordx4 v224, s[8:11], s46 offen lds
    s_add_u32 s46, s6, 0x6100
    s_add_u32 m0, s50, 0x1c00
    s_nop 0
    buffer_load_dwordx4 v240, s[8:11], s46 offen lds
    s_waitcnt vmcnt(12)
    s_barrier
    s_add_u32 s46, s7, 0x100000
    s_add_u32 m0, s44, 0x4000
    s_nop 0
    buffer_load_dwordx4 v225, s[24:27], s46 offen lds
    s_add_u32 s46, s7, 0x110000
    s_add_u32 m0, s44, 0x4400
    s_nop 0
    buffer_load_dwordx4 v225, s[24:27], s46 offen lds
    buffer_load_dwordx4 v[252:255], v228, s[16:19], s55 offen offset:1024
    ds_read_b64_tr_b16 v[216:217], v226 offset:45056
    ds_read_b64_tr_b16 v[218:219], v226 offset:45568
    v_mfma_f32_32x32x16_bf16 v[128:143], v[192:195], v[96:99], v[128:143]
    ds_read_b64_tr_b16 v[220:221], v226 offset:47104
    ds_read_b64_tr_b16 v[222:223], v226 offset:47616
    v_mfma_f32_32x32x16_bf16 v[128:143], v[196:199], v[100:103], v[128:143]
    ds_read_b64_tr_b16 v[192:193], v227 offset:32768
    ds_read_b64_tr_b16 v[194:195], v227 offset:33280
    v_mfma_f32_32x32x16_bf16 v[128:143], v[200:203], v[104:107], v[128:143]
    ds_read_b64_tr_b16 v[196:197], v227 offset:34816
    ds_read_b64_tr_b16 v[198:199], v227 offset:35328
    v_mfma_f32_32x32x16_bf16 v[128:143], v[204:207], v[108:111], v[128:143]
    ds_read_b64_tr_b16 v[200:201], v227 offset:36864
    ds_read_b64_tr_b16 v[202:203], v227 offset:37376
    v_mfma_f32_32x32x16_bf16 v[128:143], v[208:211], v[112:115], v[128:143]
    ds_read_b64_tr_b16 v[204:205], v227 offset:38912
    ds_read_b64_tr_b16 v[206:207], v227 offset:39424
    v_mfma_f32_32x32x16_bf16 v[128:143], v[212:215], v[116:119], v[128:143]
    ds_read_b64_tr_b16 v[208:209], v227 offset:40960
    ds_read_b64_tr_b16 v[210:211], v227 offset:41472
    s_waitcnt lgkmcnt(12)
    v_mfma_f32_32x32x16_bf16 v[128:143], v[216:219], v[120:123], v[128:143]
    ds_read_b64_tr_b16 v[212:213], v227 offset:43008
    ds_read_b64_tr_b16 v[214:215], v227 offset:43520
    s_waitcnt lgkmcnt(12)
    v_mfma_f32_32x32x16_bf16 v[128:143], v[220:223], v[124:127], v[128:143]
    ds_read_b64_tr_b16 v[216:217], v227 offset:45056
    ds_read_b64_tr_b16 v[218:219], v227 offset:45568
    s_waitcnt lgkmcnt(12)
    v_mfma_f32_32x32x16_bf16 v[144:159], v[192:195], v[96:99], v[144:159]
    ds_read_b64_tr_b16 v[220:221], v227 offset:47104
    ds_read_b64_tr_b16 v[222:223], v227 offset:47616
    s_waitcnt lgkmcnt(12)
    v_mfma_f32_32x32x16_bf16 v[144:159], v[196:199], v[100:103], v[144:159]
    ds_read_b64_tr_b16 v[192:193], v226 offset:49152
    ds_read_b64_tr_b16 v[194:195], v226 offset:49664
    s_waitcnt lgkmcnt(12)
    v_mfma_f32_32x32x16_bf16 v[144:159], v[200:203], v[104:107], v[144:159]
    ds_read_b64_tr_b16 v[196:197], v226 offset:51200
    ds_read_b64_tr_b16 v[198:199], v226 offset:51712
    s_waitcnt lgkmcnt(12)
    v_mfma_f32_32x32x16_bf16 v[144:159], v[204:207], v[108:111], v[144:159]
    v_cvt_pk_bf16_f32 v128, v128, v129
    v_cvt_pk_bf16_f32 v129, v130, v131
    v_cvt_pk_bf16_f32 v130, v132, v133
    v_cvt_pk_bf16_f32 v131, v134, v135
    v_cvt_pk_bf16_f32 v136, v136, v137
    v_cvt_pk_bf16_f32 v137, v138, v139
    v_cvt_pk_bf16_f32 v138, v140, v141
    v_cvt_pk_bf16_f32 v139, v142, v143
    ds_read_b64_tr_b16 v[200:201], v226 offset:53248
    ds_read_b64_tr_b16 v[202:203], v226 offset:53760
    s_waitcnt lgkmcnt(12)
    v_mfma_f32_32x32x16_bf16 v[144:159], v[208:211], v[112:115], v[144:159]
    ds_read_b64_tr_b16 v[204:205], v226 offset:55296
    ds_read_b64_tr_b16 v[206:207], v226 offset:55808
    s_waitcnt lgkmcnt(12)
    v_mfma_f32_32x32x16_bf16 v[144:159], v[212:215], v[116:119], v[144:159]
    ds_read_b64_tr_b16 v[208:209], v226 offset:57344
    ds_read_b64_tr_b16 v[210:211], v226 offset:57856
    s_waitcnt lgkmcnt(12)
    v_mfma_f32_32x32x16_bf16 v[144:159], v[216:219], v[120:123], v[144:159]
    ds_read_b64_tr_b16 v[212:213], v226 offset:59392
    ds_read_b64_tr_b16 v[214:215], v226 offset:59904
    s_waitcnt lgkmcnt(12)
    v_mfma_f32_32x32x16_bf16 v[144:159], v[220:223], v[124:127], v[144:159]
    s_waitcnt vmcnt(8)
    s_barrier
    s_add_u32 s46, s7, 0x200000
    s_add_u32 m0, s44, 0x8000
    s_nop 0
    buffer_load_dwordx4 v225, s[24:27], s46 offen lds
    s_add_u32 s46, s7, 0x210000
    s_add_u32 m0, s44, 0x8400
    s_nop 0
    buffer_load_dwordx4 v225, s[24:27], s46 offen lds
    buffer_load_dwordx4 v[252:255], v228, s[56:59], s55 offen offset:0
    s_add_u32 s46, s45, 0x1000000
    buffer_store_dwordx4 v[128:131], v228, s[28:31], s46 offen offset:0 sc1
    s_add_u32 s46, s45, 0x1000000
    buffer_store_dwordx4 v[136:139], v228, s[28:31], s46 offen offset:1024 sc1
    ds_read_b64_tr_b16 v[216:217], v226 offset:61440
    ds_read_b64_tr_b16 v[218:219], v226 offset:61952
    s_waitcnt lgkmcnt(12)
    v_mfma_f32_32x32x16_bf16 v[160:175], v[192:195], v[96:99], v[160:175]
    ds_read_b64_tr_b16 v[220:221], v226 offset:63488
    ds_read_b64_tr_b16 v[222:223], v226 offset:64000
    s_waitcnt lgkmcnt(12)
    v_mfma_f32_32x32x16_bf16 v[160:175], v[196:199], v[100:103], v[160:175]
    ds_read_b64_tr_b16 v[192:193], v227 offset:49152
    ds_read_b64_tr_b16 v[194:195], v227 offset:49664
    s_waitcnt lgkmcnt(12)
    v_mfma_f32_32x32x16_bf16 v[160:175], v[200:203], v[104:107], v[160:175]
    ds_read_b64_tr_b16 v[196:197], v227 offset:51200
    ds_read_b64_tr_b16 v[198:199], v227 offset:51712
    s_waitcnt lgkmcnt(12)
    v_mfma_f32_32x32x16_bf16 v[160:175], v[204:207], v[108:111], v[160:175]
    v_cvt_pk_bf16_f32 v144, v144, v145
    v_cvt_pk_bf16_f32 v145, v146, v147
    v_cvt_pk_bf16_f32 v146, v148, v149
    v_cvt_pk_bf16_f32 v147, v150, v151
    v_cvt_pk_bf16_f32 v152, v152, v153
    v_cvt_pk_bf16_f32 v153, v154, v155
    v_cvt_pk_bf16_f32 v154, v156, v157
    v_cvt_pk_bf16_f32 v155, v158, v159
    ds_read_b64_tr_b16 v[200:201], v227 offset:53248
    ds_read_b64_tr_b16 v[202:203], v227 offset:53760
    s_waitcnt lgkmcnt(12)
    v_mfma_f32_32x32x16_bf16 v[160:175], v[208:211], v[112:115], v[160:175]
    ds_read_b64_tr_b16 v[204:205], v227 offset:55296
    ds_read_b64_tr_b16 v[206:207], v227 offset:55808
    s_waitcnt lgkmcnt(12)
    v_mfma_f32_32x32x16_bf16 v[160:175], v[212:215], v[116:119], v[160:175]
    ds_read_b64_tr_b16 v[208:209], v227 offset:57344
    ds_read_b64_tr_b16 v[210:211], v227 offset:57856
    s_waitcnt lgkmcnt(12)
    v_mfma_f32_32x32x16_bf16 v[160:175], v[216:219], v[120:123], v[160:175]
    ds_read_b64_tr_b16 v[212:213], v227 offset:59392
    ds_read_b64_tr_b16 v[214:215], v227 offset:59904
    s_waitcnt lgkmcnt(12)
    v_mfma_f32_32x32x16_bf16 v[160:175], v[220:223], v[124:127], v[160:175]
    ds_read_b64_tr_b16 v[216:217], v227 offset:61440
    ds_read_b64_tr_b16 v[218:219], v227 offset:61952
    s_waitcnt lgkmcnt(12)
    v_mfma_f32_32x32x16_bf16 v[176:191], v[192:195], v[96:99], v[176:191]
    ds_read_b64_tr_b16 v[220:221], v227 offset:63488
    ds_read_b64_tr_b16 v[222:223], v227 offset:64000
    s_waitcnt lgkmcnt(12)
    v_mfma_f32_32x32x16_bf16 v[176:191], v[196:199], v[100:103], v[176:191]
    ds_read_b64_tr_b16 v[192:193], v226 offset:0
    ds_read_b64_tr_b16 v[194:195], v226 offset:512
    s_waitcnt lgkmcnt(12)
    v_mfma_f32_32x32x16_bf16 v[176:191], v[200:203], v[104:107], v[176:191]
    ds_read_b64_tr_b16 v[196:197], v226 offset:2048
    ds_read_b64_tr_b16 v[198:199], v226 offset:2560
    s_waitcnt lgkmcnt(12)
    v_mfma_f32_32x32x16_bf16 v[176:191], v[204:207], v[108:111], v[176:191]
    v_cvt_pk_bf16_f32 v160, v160, v161
    v_cvt_pk_bf16_f32 v161, v162, v163
    v_cvt_pk_bf16_f32 v162, v164, v165
    v_cvt_pk_bf16_f32 v163, v166, v167
    v_cvt_pk_bf16_f32 v168, v168, v169
    v_cvt_pk_bf16_f32 v169, v170, v171
    v_cvt_pk_bf16_f32 v170, v172, v173
    v_cvt_pk_bf16_f32 v171, v174, v175
    ds_read_b64_tr_b16 v[200:201], v226 offset:4096
    ds_read_b64_tr_b16 v[202:203], v226 offset:4608
    s_waitcnt lgkmcnt(12)
    v_mfma_f32_32x32x16_bf16 v[176:191], v[208:211], v[112:115], v[176:191]
    ds_read_b64_tr_b16 v[204:205], v226 offset:6144
    ds_read_b64_tr_b16 v[206:207], v226 offset:6656
    s_waitcnt lgkmcnt(12)
    v_mfma_f32_32x32x16_bf16 v[176:191], v[212:215], v[116:119], v[176:191]
    ds_read_b64_tr_b16 v[208:209], v226 offset:8192
    ds_read_b64_tr_b16 v[210:211], v226 offset:8704
    s_waitcnt lgkmcnt(12)
    v_mfma_f32_32x32x16_bf16 v[176:191], v[216:219], v[120:123], v[176:191]
    ds_read_b64_tr_b16 v[212:213], v226 offset:10240
    ds_read_b64_tr_b16 v[214:215], v226 offset:10752
    s_waitcnt lgkmcnt(12)
    v_mfma_f32_32x32x16_bf16 v[176:191], v[220:223], v[124:127], v[176:191]
    s_waitcnt vmcnt(6)
    s_barrier
    s_add_u32 s46, s7, 0x300000
    s_add_u32 m0, s44, 0xc000
    s_nop 0
    buffer_load_dwordx4 v225, s[24:27], s46 offen lds
    s_add_u32 s46, s7, 0x310000
    s_add_u32 m0, s44, 0xc400
    s_nop 0
    buffer_load_dwordx4 v225, s[24:27], s46 offen lds
    buffer_load_dwordx4 v[252:255], v228, s[56:59], s55 offen offset:1024
    s_add_u32 s46, s45, 0x1000000
    buffer_store_dwordx4 v[144:147], v228, s[28:31], s46 offen offset:2048 sc1
    s_add_u32 s46, s45, 0x1000000
    buffer_store_dwordx4 v[152:155], v228, s[28:31], s46 offen offset:3072 sc1
    ds_read_b64_tr_b16 v[216:217], v226 offset:12288
    ds_read_b64_tr_b16 v[218:219], v226 offset:12800
    s_waitcnt lgkmcnt(12)
    v_mfma_f32_32x32x16_bf16 v[128:143], v[0:3], v[192:195], 0
    ds_read_b64_tr_b16 v[220:221], v226 offset:14336
    ds_read_b64_tr_b16 v[222:223], v226 offset:14848
    s_waitcnt lgkmcnt(12)
    v_mfma_f32_32x32x16_bf16 v[128:143], v[4:7], v[196:199], v[128:143]
    ds_read_b64_tr_b16 v[192:193], v227 offset:0
    ds_read_b64_tr_b16 v[194:195], v227 offset:512
    s_waitcnt lgkmcnt(12)
    v_mfma_f32_32x32x16_bf16 v[128:143], v[8:11], v[200:203], v[128:143]
    ds_read_b64_tr_b16 v[196:197], v227 offset:2048
    ds_read_b64_tr_b16 v[198:199], v227 offset:2560
    s_waitcnt lgkmcnt(12)
    v_mfma_f32_32x32x16_bf16 v[128:143], v[12:15], v[204:207], v[128:143]
    v_cvt_pk_bf16_f32 v176, v176, v177
    v_cvt_pk_bf16_f32 v177, v178, v179
    v_cvt_pk_bf16_f32 v178, v180, v181
    v_cvt_pk_bf16_f32 v179, v182, v183
    v_cvt_pk_bf16_f32 v184, v184, v185
    v_cvt_pk_bf16_f32 v185, v186, v187
    v_cvt_pk_bf16_f32 v186, v188, v189
    v_cvt_pk_bf16_f32 v187, v190, v191
    ds_read_b64_tr_b16 v[200:201], v227 offset:4096
    ds_read_b64_tr_b16 v[202:203], v227 offset:4608
    s_waitcnt lgkmcnt(12)
    v_mfma_f32_32x32x16_bf16 v[128:143], v[16:19], v[208:211], v[128:143]
    ds_read_b64_tr_b16 v[204:205], v227 offset:6144
    ds_read_b64_tr_b16 v[206:207], v227 offset:6656
    s_waitcnt lgkmcnt(12)
    v_mfma_f32_32x32x16_bf16 v[128:143], v[20:23], v[212:215], v[128:143]
    ds_read_b64_tr_b16 v[208:209], v227 offset:8192
    ds_read_b64_tr_b16 v[210:211], v227 offset:8704
    s_waitcnt lgkmcnt(12)
    v_mfma_f32_32x32x16_bf16 v[128:143], v[24:27], v[216:219], v[128:143]
    ds_read_b64_tr_b16 v[212:213], v227 offset:10240
    ds_read_b64_tr_b16 v[214:215], v227 offset:10752
    s_waitcnt lgkmcnt(12)
    v_mfma_f32_32x32x16_bf16 v[128:143], v[28:31], v[220:223], v[128:143]
    ds_read_b64_tr_b16 v[216:217], v227 offset:12288
    ds_read_b64_tr_b16 v[218:219], v227 offset:12800
    s_waitcnt lgkmcnt(12)
    v_mfma_f32_32x32x16_bf16 v[144:159], v[0:3], v[192:195], 0
    ds_read_b64_tr_b16 v[220:221], v227 offset:14336
    ds_read_b64_tr_b16 v[222:223], v227 offset:14848
    s_waitcnt lgkmcnt(12)
    v_mfma_f32_32x32x16_bf16 v[144:159], v[4:7], v[196:199], v[144:159]
    ds_read_b64_tr_b16 v[192:193], v226 offset:16384
    ds_read_b64_tr_b16 v[194:195], v226 offset:16896
    s_waitcnt lgkmcnt(12)
    v_mfma_f32_32x32x16_bf16 v[144:159], v[8:11], v[200:203], v[144:159]
    ds_read_b64_tr_b16 v[196:197], v226 offset:18432
    ds_read_b64_tr_b16 v[198:199], v226 offset:18944
    s_waitcnt lgkmcnt(12)
    v_mfma_f32_32x32x16_bf16 v[144:159], v[12:15], v[204:207], v[144:159]
    ds_read_b64_tr_b16 v[200:201], v226 offset:20480
    ds_read_b64_tr_b16 v[202:203], v226 offset:20992
    s_waitcnt lgkmcnt(12)
    v_mfma_f32_32x32x16_bf16 v[144:159], v[16:19], v[208:211], v[144:159]
    ds_read_b64_tr_b16 v[204:205], v226 offset:22528
    ds_read_b64_tr_b16 v[206:207], v226 offset:23040
    s_waitcnt lgkmcnt(12)
    v_mfma_f32_32x32x16_bf16 v[144:159], v[20:23], v[212:215], v[144:159]
    ds_read_b64_tr_b16 v[208:209], v226 offset:24576
    ds_read_b64_tr_b16 v[210:211], v226 offset:25088
    s_waitcnt lgkmcnt(12)
    v_mfma_f32_32x32x16_bf16 v[144:159], v[24:27], v[216:219], v[144:159]
    ds_read_b64_tr_b16 v[212:213], v226 offset:26624
    ds_read_b64_tr_b16 v[214:215], v226 offset:27136
    s_waitcnt lgkmcnt(12)
    v_mfma_f32_32x32x16_bf16 v[144:159], v[28:31], v[220:223], v[144:159]
    s_waitcnt vmcnt(8)
    s_barrier
    s_add_u32 s46, s7, 0x80
    s_add_u32 m0, s44, 0x0
    s_nop 0
    buffer_load_dwordx4 v225, s[24:27], s46 offen lds
    s_add_u32 s46, s7, 0x10080
    s_add_u32 m0, s44, 0x400
    s_nop 0
    buffer_load_dwordx4 v225, s[24:27], s46 offen lds
    buffer_load_dwordx4 v[252:255], v228, s[60:63], s66 offen
    s_add_u32 s46, s45, 0x1001000
    buffer_store_dwordx4 v[160:163], v228, s[28:31], s46 offen offset:0 sc1
    ds_read_b64_tr_b16 v[216:217], v226 offset:28672
    ds_read_b64_tr_b16 v[218:219], v226 offset:29184
    s_waitcnt lgkmcnt(12)
    v_mfma_f32_32x32x16_bf16 v[128:143], v[32:35], v[192:195], v[128:143]
    ds_read_b64_tr_b16 v[220:221], v226 offset:30720
    ds_read_b64_tr_b16 v[222:223], v226 offset:31232
    s_waitcnt lgkmcnt(12)
    v_mfma_f32_32x32x16_bf16 v[128:143], v[36:39], v[196:199], v[128:143]
    ds_read_b64_tr_b16 v[192:193], v227 offset:16384
    ds_read_b64_tr_b16 v[194:195], v227 offset:16896
    s_waitcnt lgkmcnt(12)
    v_mfma_f32_32x32x16_bf16 v[128:143], v[40:43], v[200:203], v[128:143]
    ds_read_b64_tr_b16 v[196:197], v227 offset:18432
    ds_read_b64_tr_b16 v[198:199], v227 offset:18944
    s_waitcnt lgkmcnt(12)
    v_mfma_f32_32x32x16_bf16 v[128:143], v[44:47], v[204:207], v[128:143]
    ds_read_b64_tr_b16 v[200:201], v227 offset:20480
    ds_read_b64_tr_b16 v[202:203], v227 offset:20992
    s_waitcnt lgkmcnt(12)
    v_mfma_f32_32x32x16_bf16 v[128:143], v[48:51], v[208:211], v[128:143]
    ds_read_b64_tr_b16 v[204:205], v227 offset:22528
    ds_read_b64_tr_b16 v[206:207], v227 offset:23040
    s_waitcnt lgkmcnt(12)
    v_mfma_f32_32x32x16_bf16 v[128:143], v[52:55], v[212:215], v[128:143]
    ds_read_b64_tr_b16 v[208:209], v227 offset:24576
    ds_read_b64_tr_b16 v[210:211], v227 offset:25088
    s_waitcnt lgkmcnt(12)
    v_mfma_f32_32x32x16_bf16 v[128:143], v[56:59], v[216:219], v[128:143]
    ds_read_b64_tr_b16 v[212:213], v227 offset:26624
    ds_read_b64_tr_b16 v[214:215], v227 offset:27136
    s_waitcnt lgkmcnt(12)
    v_mfma_f32_32x32x16_bf16 v[128:143], v[60:63], v[220:223], v[128:143]
    ds_read_b64_tr_b16 v[216:217], v227 offset:28672
    ds_read_b64_tr_b16 v[218:219], v227 offset:29184
    s_waitcnt lgkmcnt(12)
    v_mfma_f32_32x32x16_bf16 v[144:159], v[32:35], v[192:195], v[144:159]
    ds_read_b64_tr_b16 v[220:221], v227 offset:30720
    ds_read_b64_tr_b16 v[222:223], v227 offset:31232
    s_waitcnt lgkmcnt(12)
    v_mfma_f32_32x32x16_bf16 v[144:159], v[36:39], v[196:199], v[144:159]
    ds_read_b64_tr_b16 v[192:193], v226 offset:32768
    ds_read_b64_tr_b16 v[194:195], v226 offset:33280
    s_waitcnt lgkmcnt(12)
    v_mfma_f32_32x32x16_bf16 v[144:159], v[40:43], v[200:203], v[144:159]
    ds_read_b64_tr_b16 v[196:197], v226 offset:34816
    ds_read_b64_tr_b16 v[198:199], v226 offset:35328
    s_waitcnt lgkmcnt(12)
    v_mfma_f32_32x32x16_bf16 v[144:159], v[44:47], v[204:207], v[144:159]
    ds_read_b64_tr_b16 v[200:201], v226 offset:36864
    ds_read_b64_tr_b16 v[202:203], v226 offset:37376
    s_waitcnt lgkmcnt(12)
    v_mfma_f32_32x32x16_bf16 v[144:159], v[48:51], v[208:211], v[144:159]
    ds_read_b64_tr_b16 v[204:205], v226 offset:38912
    ds_read_b64_tr_b16 v[206:207], v226 offset:39424
    s_waitcnt lgkmcnt(12)
    v_mfma_f32_32x32x16_bf16 v[144:159], v[52:55], v[212:215], v[144:159]
    ds_read_b64_tr_b16 v[208:209], v226 offset:40960
    ds_read_b64_tr_b16 v[210:211], v226 offset:41472
    s_waitcnt lgkmcnt(12)
    v_mfma_f32_32x32x16_bf16 v[144:159], v[56:59], v[216:219], v[144:159]
    ds_read_b64_tr_b16 v[212:213], v226 offset:43008
    ds_read_b64_tr_b16 v[214:215], v226 offset:43520
    s_waitcnt lgkmcnt(12)
    v_mfma_f32_32x32x16_bf16 v[144:159], v[60:63], v[220:223], v[144:159]
    s_waitcnt vmcnt(7)
    s_barrier
    s_add_u32 s46, s7, 0x100080
    s_add_u32 m0, s44, 0x4000
    s_nop 0
    buffer_load_dwordx4 v225, s[24:27], s46 offen lds
    s_add_u32 s46, s7, 0x110080
    s_add_u32 m0, s44, 0x4400
    s_nop 0
    buffer_load_dwordx4 v225, s[24:27], s46 offen lds
    s_add_u32 s46, s45, 0x1001000
    buffer_store_dwordx4 v[168:171], v228, s[28:31], s46 offen offset:1024 sc1
    ds_read_b64_tr_b16 v[216:217], v226 offset:45056
    ds_read_b64_tr_b16 v[218:219], v226 offset:45568
    s_waitcnt lgkmcnt(12)
    v_mfma_f32_32x32x16_bf16 v[128:143], v[64:67], v[192:195], v[128:143]
    ds_read_b64_tr_b16 v[220:221], v226 offset:47104
    ds_read_b64_tr_b16 v[222:223], v226 offset:47616
    s_waitcnt lgkmcnt(12)
    v_mfma_f32_32x32x16_bf16 v[128:143], v[68:71], v[196:199], v[128:143]
    ds_read_b64_tr_b16 v[192:193], v227 offset:32768
    ds_read_b64_tr_b16 v[194:195], v227 offset:33280
    s_waitcnt lgkmcnt(12)
    v_mfma_f32_32x32x16_bf16 v[128:143], v[72:75], v[200:203], v[128:143]
    ds_read_b64_tr_b16 v[196:197], v227 offset:34816
    ds_read_b64_tr_b16 v[198:199], v227 offset:35328
    s_waitcnt lgkmcnt(12)
    v_mfma_f32_32x32x16_bf16 v[128:143], v[76:79], v[204:207], v[128:143]
    ds_read_b64_tr_b16 v[200:201], v227 offset:36864
    ds_read_b64_tr_b16 v[202:203], v227 offset:37376
    s_waitcnt lgkmcnt(12)
    v_mfma_f32_32x32x16_bf16 v[128:143], v[80:83], v[208:211], v[128:143]
    ds_read_b64_tr_b16 v[204:205], v227 offset:38912
    ds_read_b64_tr_b16 v[206:207], v227 offset:39424
    s_waitcnt lgkmcnt(12)
    v_mfma_f32_32x32x16_bf16 v[128:143], v[84:87], v[212:215], v[128:143]
    ds_read_b64_tr_b16 v[208:209], v227 offset:40960
    ds_read_b64_tr_b16 v[210:211], v227 offset:41472
    s_waitcnt lgkmcnt(12)
    v_mfma_f32_32x32x16_bf16 v[128:143], v[88:91], v[216:219], v[128:143]
    ds_read_b64_tr_b16 v[212:213], v227 offset:43008
    ds_read_b64_tr_b16 v[214:215], v227 offset:43520
    s_waitcnt lgkmcnt(12)
    v_mfma_f32_32x32x16_bf16 v[128:143], v[92:95], v[220:223], v[128:143]
    ds_read_b64_tr_b16 v[216:217], v227 offset:45056
    ds_read_b64_tr_b16 v[218:219], v227 offset:45568
    s_waitcnt lgkmcnt(12)
    v_mfma_f32_32x32x16_bf16 v[144:159], v[64:67], v[192:195], v[144:159]
    ds_read_b64_tr_b16 v[220:221], v227 offset:47104
    ds_read_b64_tr_b16 v[222:223], v227 offset:47616
    s_waitcnt lgkmcnt(12)
    v_mfma_f32_32x32x16_bf16 v[144:159], v[68:71], v[196:199], v[144:159]
    ds_read_b64_tr_b16 v[192:193], v226 offset:49152
    ds_read_b64_tr_b16 v[194:195], v226 offset:49664
    s_waitcnt lgkmcnt(12)
    v_mfma_f32_32x32x16_bf16 v[144:159], v[72:75], v[200:203], v[144:159]
    ds_read_b64_tr_b16 v[196:197], v226 offset:51200
    ds_read_b64_tr_b16 v[198:199], v226 offset:51712
    s_waitcnt lgkmcnt(12)
    v_mfma_f32_32x32x16_bf16 v[144:159], v[76:79], v[204:207], v[144:159]
    ds_read_b64_tr_b16 v[200:201], v226 offset:53248
    ds_read_b64_tr_b16 v[202:203], v226 offset:53760
    s_waitcnt lgkmcnt(12)
    v_mfma_f32_32x32x16_bf16 v[144:159], v[80:83], v[208:211], v[144:159]
    ds_read_b64_tr_b16 v[204:205], v226 offset:55296
    ds_read_b64_tr_b16 v[206:207], v226 offset:55808
    s_waitcnt lgkmcnt(12)
    v_mfma_f32_32x32x16_bf16 v[144:159], v[84:87], v[212:215], v[144:159]
    ds_read_b64_tr_b16 v[208:209], v226 offset:57344
    ds_read_b64_tr_b16 v[210:211], v226 offset:57856
    s_waitcnt lgkmcnt(12)
    v_mfma_f32_32x32x16_bf16 v[144:159], v[88:91], v[216:219], v[144:159]
    ds_read_b64_tr_b16 v[212:213], v226 offset:59392
    ds_read_b64_tr_b16 v[214:215], v226 offset:59904
    s_waitcnt lgkmcnt(12)
    v_mfma_f32_32x32x16_bf16 v[144:159], v[92:95], v[220:223], v[144:159]
    s_waitcnt vmcnt(5)
    s_barrier
    s_add_u32 s46, s7, 0x200080
    s_add_u32 m0, s44, 0x8000
    s_nop 0
    buffer_load_dwordx4 v225, s[24:27], s46 offen lds
    s_add_u32 s46, s7, 0x210080
    s_add_u32 m0, s44, 0x8400
    s_nop 0
    buffer_load_dwordx4 v225, s[24:27], s46 offen lds
    s_add_u32 s46, s45, 0x1001000
    buffer_store_dwordx4 v[176:179], v228, s[28:31], s46 offen offset:2048 sc1
    s_add_u32 s46, s45, 0x1001000
    buffer_store_dwordx4 v[184:187], v228, s[28:31], s46 offen offset:3072 sc1
    ds_read_b64_tr_b16 v[216:217], v226 offset:61440
    ds_read_b64_tr_b16 v[218:219], v226 offset:61952
    s_waitcnt lgkmcnt(12)
    v_mfma_f32_32x32x16_bf16 v[128:143], v[96:99], v[192:195], v[128:143]
    ds_read_b64_tr_b16 v[220:221], v226 offset:63488
    ds_read_b64_tr_b16 v[222:223], v226 offset:64000
    s_waitcnt lgkmcnt(12)
    v_mfma_f32_32x32x16_bf16 v[128:143], v[100:103], v[196:199], v[128:143]
    ds_read_b64_tr_b16 v[192:193], v227 offset:49152
    ds_read_b64_tr_b16 v[194:195], v227 offset:49664
    s_waitcnt lgkmcnt(12)
    v_mfma_f32_32x32x16_bf16 v[128:143], v[104:107], v[200:203], v[128:143]
    ds_read_b64_tr_b16 v[196:197], v227 offset:51200
    ds_read_b64_tr_b16 v[198:199], v227 offset:51712
    s_waitcnt lgkmcnt(12)
    v_mfma_f32_32x32x16_bf16 v[128:143], v[108:111], v[204:207], v[128:143]
    ds_read_b64_tr_b16 v[200:201], v227 offset:53248
    ds_read_b64_tr_b16 v[202:203], v227 offset:53760
    s_waitcnt lgkmcnt(12)
    v_mfma_f32_32x32x16_bf16 v[128:143], v[112:115], v[208:211], v[128:143]
    ds_read_b64_tr_b16 v[204:205], v227 offset:55296
    ds_read_b64_tr_b16 v[206:207], v227 offset:55808
    s_waitcnt lgkmcnt(12)
    v_mfma_f32_32x32x16_bf16 v[128:143], v[116:119], v[212:215], v[128:143]
    ds_read_b64_tr_b16 v[208:209], v227 offset:57344
    ds_read_b64_tr_b16 v[210:211], v227 offset:57856
    s_waitcnt lgkmcnt(12)
    v_mfma_f32_32x32x16_bf16 v[128:143], v[120:123], v[216:219], v[128:143]
    ds_read_b64_tr_b16 v[212:213], v227 offset:59392
    ds_read_b64_tr_b16 v[214:215], v227 offset:59904
    s_waitcnt lgkmcnt(12)
    v_mfma_f32_32x32x16_bf16 v[128:143], v[124:127], v[220:223], v[128:143]
    ds_read_b64_tr_b16 v[216:217], v227 offset:61440
    ds_read_b64_tr_b16 v[218:219], v227 offset:61952
    s_waitcnt lgkmcnt(12)
    v_mfma_f32_32x32x16_bf16 v[144:159], v[96:99], v[192:195], v[144:159]
    ds_read_b64_tr_b16 v[220:221], v227 offset:63488
    ds_read_b64_tr_b16 v[222:223], v227 offset:64000
    s_waitcnt lgkmcnt(12)
    v_mfma_f32_32x32x16_bf16 v[144:159], v[100:103], v[196:199], v[144:159]
    ds_read_b64_tr_b16 v[192:193], v226 offset:0
    ds_read_b64_tr_b16 v[194:195], v226 offset:512
    s_waitcnt lgkmcnt(12)
    v_mfma_f32_32x32x16_bf16 v[144:159], v[104:107], v[200:203], v[144:159]
    ds_read_b64_tr_b16 v[196:197], v226 offset:2048
    ds_read_b64_tr_b16 v[198:199], v226 offset:2560
    s_waitcnt lgkmcnt(12)
    v_mfma_f32_32x32x16_bf16 v[144:159], v[108:111], v[204:207], v[144:159]
    v_cvt_pk_bf16_f32 v128, v128, v129
    v_cvt_pk_bf16_f32 v129, v130, v131
    v_cvt_pk_bf16_f32 v130, v132, v133
    v_cvt_pk_bf16_f32 v131, v134, v135
    v_cvt_pk_bf16_f32 v136, v136, v137
    v_cvt_pk_bf16_f32 v137, v138, v139
    v_cvt_pk_bf16_f32 v138, v140, v141
    v_cvt_pk_bf16_f32 v139, v142, v143
    ds_read_b64_tr_b16 v[200:201], v226 offset:4096
    ds_read_b64_tr_b16 v[202:203], v226 offset:4608
    s_waitcnt lgkmcnt(12)
    v_mfma_f32_32x32x16_bf16 v[144:159], v[112:115], v[208:211], v[144:159]
    ds_read_b64_tr_b16 v[204:205], v226 offset:6144
    ds_read_b64_tr_b16 v[206:207], v226 offset:6656
    s_waitcnt lgkmcnt(12)
    v_mfma_f32_32x32x16_bf16 v[144:159], v[116:119], v[212:215], v[144:159]
    ds_read_b64_tr_b16 v[208:209], v226 offset:8192
    ds_read_b64_tr_b16 v[210:211], v226 offset:8704
    s_waitcnt lgkmcnt(12)
    v_mfma_f32_32x32x16_bf16 v[144:159], v[120:123], v[216:219], v[144:159]
    ds_read_b64_tr_b16 v[212:213], v226 offset:10240
    ds_read_b64_tr_b16 v[214:215], v226 offset:10752
    s_waitcnt lgkmcnt(12)
    v_mfma_f32_32x32x16_bf16 v[144:159], v[124:127], v[220:223], v[144:159]
    s_waitcnt vmcnt(5)
    s_barrier
    s_add_u32 s46, s7, 0x300080
    s_add_u32 m0, s44, 0xc000
    s_nop 0
    buffer_load_dwordx4 v225, s[24:27], s46 offen lds
    s_add_u32 s46, s7, 0x310080
    s_add_u32 m0, s44, 0xc400
    s_nop 0
    buffer_load_dwordx4 v225, s[24:27], s46 offen lds
    ds_read_b64_tr_b16 v[216:217], v226 offset:12288
    ds_read_b64_tr_b16 v[218:219], v226 offset:12800
    s_waitcnt lgkmcnt(12)
    v_mfma_f32_32x32x16_bf16 v[160:175], v[0:3], v[192:195], 0
    ds_read_b64_tr_b16 v[220:221], v226 offset:14336
    ds_read_b64_tr_b16 v[222:223], v226 offset:14848
    s_waitcnt lgkmcnt(12)
    v_mfma_f32_32x32x16_bf16 v[160:175], v[4:7], v[196:199], v[160:175]
    ds_read_b64_tr_b16 v[192:193], v227 offset:0
    ds_read_b64_tr_b16 v[194:195], v227 offset:512
    s_waitcnt lgkmcnt(12)
    v_mfma_f32_32x32x16_bf16 v[160:175], v[8:11], v[200:203], v[160:175]
    ds_read_b64_tr_b16 v[196:197], v227 offset:2048
    ds_read_b64_tr_b16 v[198:199], v227 offset:2560
    s_waitcnt lgkmcnt(12)
    v_mfma_f32_32x32x16_bf16 v[160:175], v[12:15], v[204:207], v[160:175]
    v_cvt_pk_bf16_f32 v144, v144, v145
    v_cvt_pk_bf16_f32 v145, v146, v147
    v_cvt_pk_bf16_f32 v146, v148, v149
    v_cvt_pk_bf16_f32 v147, v150, v151
    v_cvt_pk_bf16_f32 v152, v152, v153
    v_cvt_pk_bf16_f32 v153, v154, v155
    v_cvt_pk_bf16_f32 v154, v156, v157
    v_cvt_pk_bf16_f32 v155, v158, v159
    ds_read_b64_tr_b16 v[200:201], v227 offset:4096
    ds_read_b64_tr_b16 v[202:203], v227 offset:4608
    s_waitcnt lgkmcnt(12)
    v_mfma_f32_32x32x16_bf16 v[160:175], v[16:19], v[208:211], v[160:175]
    ds_read_b64_tr_b16 v[204:205], v227 offset:6144
    ds_read_b64_tr_b16 v[206:207], v227 offset:6656
    s_waitcnt lgkmcnt(12)
    v_mfma_f32_32x32x16_bf16 v[160:175], v[20:23], v[212:215], v[160:175]
    ds_read_b64_tr_b16 v[208:209], v227 offset:8192
    ds_read_b64_tr_b16 v[210:211], v227 offset:8704
    s_waitcnt lgkmcnt(12)
    v_mfma_f32_32x32x16_bf16 v[160:175], v[24:27], v[216:219], v[160:175]
    ds_read_b64_tr_b16 v[212:213], v227 offset:10240
    ds_read_b64_tr_b16 v[214:215], v227 offset:10752
    s_waitcnt lgkmcnt(12)
    v_mfma_f32_32x32x16_bf16 v[160:175], v[28:31], v[220:223], v[160:175]
    ds_read_b64_tr_b16 v[216:217], v227 offset:12288
    ds_read_b64_tr_b16 v[218:219], v227 offset:12800
    s_waitcnt lgkmcnt(12)
    v_mfma_f32_32x32x16_bf16 v[176:191], v[0:3], v[192:195], 0
    ds_read_b64_tr_b16 v[220:221], v227 offset:14336
    ds_read_b64_tr_b16 v[222:223], v227 offset:14848
    s_waitcnt lgkmcnt(12)
    v_mfma_f32_32x32x16_bf16 v[176:191], v[4:7], v[196:199], v[176:191]
    ds_read_b64_tr_b16 v[192:193], v226 offset:16384
    ds_read_b64_tr_b16 v[194:195], v226 offset:16896
    s_waitcnt lgkmcnt(12)
    v_mfma_f32_32x32x16_bf16 v[176:191], v[8:11], v[200:203], v[176:191]
    ds_read_b64_tr_b16 v[196:197], v226 offset:18432
    ds_read_b64_tr_b16 v[198:199], v226 offset:18944
    s_waitcnt lgkmcnt(12)
    v_mfma_f32_32x32x16_bf16 v[176:191], v[12:15], v[204:207], v[176:191]
    ds_read_b64_tr_b16 v[200:201], v226 offset:20480
    ds_read_b64_tr_b16 v[202:203], v226 offset:20992
    s_waitcnt lgkmcnt(12)
    v_mfma_f32_32x32x16_bf16 v[176:191], v[16:19], v[208:211], v[176:191]
    ds_read_b64_tr_b16 v[204:205], v226 offset:22528
    ds_read_b64_tr_b16 v[206:207], v226 offset:23040
    s_waitcnt lgkmcnt(12)
    v_mfma_f32_32x32x16_bf16 v[176:191], v[20:23], v[212:215], v[176:191]
    ds_read_b64_tr_b16 v[208:209], v226 offset:24576
    ds_read_b64_tr_b16 v[210:211], v226 offset:25088
    s_waitcnt lgkmcnt(12)
    v_mfma_f32_32x32x16_bf16 v[176:191], v[24:27], v[216:219], v[176:191]
    ds_read_b64_tr_b16 v[212:213], v226 offset:26624
    ds_read_b64_tr_b16 v[214:215], v226 offset:27136
    s_waitcnt lgkmcnt(12)
    v_mfma_f32_32x32x16_bf16 v[176:191], v[28:31], v[220:223], v[176:191]
    ds_read_b128 v[0:3], v229 offset:8192
    ds_read_b128 v[4:7], v230 offset:8192
    ds_read_b128 v[8:11], v231 offset:8192
    ds_read_b128 v[12:15], v232 offset:8192
    s_waitcnt lgkmcnt(0)
    s_add_u32 s46, s6, 0x180
    s_add_u32 m0, s50, 0x2000
    s_nop 0
    buffer_load_dwordx4 v224, s[8:11], s46 offen lds
    s_add_u32 s46, s6, 0x2180
    s_add_u32 m0, s50, 0x2400
    s_nop 0
    buffer_load_dwordx4 v240, s[8:11], s46 offen lds
    s_add_u32 s46, s6, 0x4180
    s_add_u32 m0, s50, 0x2800
    s_nop 0
    buffer_load_dwordx4 v224, s[8:11], s46 offen lds
    s_add_u32 s46, s6, 0x6180
    s_add_u32 m0, s50, 0x2c00
    s_nop 0
    buffer_load_dwordx4 v240, s[8:11], s46 offen lds
    ds_read_b128 v[16:19], v229 offset:0
    ds_read_b128 v[20:23], v230 offset:0
    ds_read_b128 v[24:27], v231 offset:0
    ds_read_b128 v[28:31], v232 offset:0
    s_waitcnt lgkmcnt(0)
    s_add_u32 s46, s6, 0x200
    s_add_u32 m0, s50, 0x0
    s_nop 0
    buffer_load_dwordx4 v224, s[8:11], s46 offen lds
    s_add_u32 s46, s6, 0x2200
    s_add_u32 m0, s50, 0x400
    s_nop 0
    buffer_load_dwordx4 v240, s[8:11], s46 offen lds
    s_add_u32 s46, s6, 0x4200
    s_add_u32 m0, s50, 0x800
    s_nop 0
    buffer_load_dwordx4 v224, s[8:11], s46 offen lds
    s_add_u32 s46, s6, 0x6200
    s_add_u32 m0, s50, 0xc00
    s_nop 0
    buffer_load_dwordx4 v240, s[8:11], s46 offen lds
    s_waitcnt vmcnt(12)
    s_barrier
    s_add_u32 s46, s7, 0x0
    s_add_u32 m0, s44, 0x0
    s_nop 0
    buffer_load_dwordx4 v225, s[16:19], s46 offen lds
    s_add_u32 s46, s7, 0x10000
    s_add_u32 m0, s44, 0x400
    s_nop 0
    buffer_load_dwordx4 v225, s[16:19], s46 offen lds
    s_add_u32 s46, s48, 0x0
    buffer_store_dwordx4 v[128:131], v228, s[28:31], s46 offen offset:0 sc1
    ds_read_b64_tr_b16 v[216:217], v226 offset:28672
    ds_read_b64_tr_b16 v[218:219], v226 offset:29184
    v_mfma_f32_32x32x16_bf16 v[160:175], v[32:35], v[192:195], v[160:175]
    ds_read_b64_tr_b16 v[220:221], v226 offset:30720
    ds_read_b64_tr_b16 v[222:223], v226 offset:31232
    v_mfma_f32_32x32x16_bf16 v[160:175], v[36:39], v[196:199], v[160:175]
    ds_read_b64_tr_b16 v[192:193], v227 offset:16384
    ds_read_b64_tr_b16 v[194:195], v227 offset:16896
    v_mfma_f32_32x32x16_bf16 v[160:175], v[40:43], v[200:203], v[160:175]
    ds_read_b64_tr_b16 v[196:197], v227 offset:18432
    ds_read_b64_tr_b16 v[198:199], v227 offset:18944
    v_mfma_f32_32x32x16_bf16 v[160:175], v[44:47], v[204:207], v[160:175]
    ds_read_b64_tr_b16 v[200:201], v227 offset:20480
    ds_read_b64_tr_b16 v[202:203], v227 offset:20992
    v_mfma_f32_32x32x16_bf16 v[160:175], v[48:51], v[208:211], v[160:175]
    ds_read_b64_tr_b16 v[204:205], v227 offset:22528
    ds_read_b64_tr_b16 v[206:207], v227 offset:23040
    v_mfma_f32_32x32x16_bf16 v[160:175], v[52:55], v[212:215], v[160:175]
    ds_read_b64_tr_b16 v[208:209], v227 offset:24576
    ds_read_b64_tr_b16 v[210:211], v227 offset:25088
    s_waitcnt lgkmcnt(12)
    v_mfma_f32_32x32x16_bf16 v[160:175], v[56:59], v[216:219], v[160:175]
    ds_read_b64_tr_b16 v[212:213], v227 offset:26624
    ds_read_b64_tr_b16 v[214:215], v227 offset:27136
    s_waitcnt lgkmcnt(12)
    v_mfma_f32_32x32x16_bf16 v[160:175], v[60:63], v[220:223], v[160:175]
    ds_read_b64_tr_b16 v[216:217], v227 offset:28672
    ds_read_b64_tr_b16 v[218:219], v227 offset:29184
    s_waitcnt lgkmcnt(12)
    v_mfma_f32_32x32x16_bf16 v[176:191], v[32:35], v[192:195], v[176:191]
    ds_read_b64_tr_b16 v[220:221], v227 offset:30720
    ds_read_b64_tr_b16 v[222:223], v227 offset:31232
    s_waitcnt lgkmcnt(12)
    v_mfma_f32_32x32x16_bf16 v[176:191], v[36:39], v[196:199], v[176:191]
    ds_read_b64_tr_b16 v[192:193], v226 offset:32768
    ds_read_b64_tr_b16 v[194:195], v226 offset:33280
    s_waitcnt lgkmcnt(12)
    v_mfma_f32_32x32x16_bf16 v[176:191], v[40:43], v[200:203], v[176:191]
    ds_read_b64_tr_b16 v[196:197], v226 offset:34816
    ds_read_b64_tr_b16 v[198:199], v226 offset:35328
    s_waitcnt lgkmcnt(12)
    v_mfma_f32_32x32x16_bf16 v[176:191], v[44:47], v[204:207], v[176:191]
    ds_read_b64_tr_b16 v[200:201], v226 offset:36864
    ds_read_b64_tr_b16 v[202:203], v226 offset:37376
    s_waitcnt lgkmcnt(12)
    v_mfma_f32_32x32x16_bf16 v[176:191], v[48:51], v[208:211], v[176:191]
    ds_read_b64_tr_b16 v[204:205], v226 offset:38912
    ds_read_b64_tr_b16 v[206:207], v226 offset:39424
    s_waitcnt lgkmcnt(12)
    v_mfma_f32_32x32x16_bf16 v[176:191], v[52:55], v[212:215], v[176:191]
    ds_read_b64_tr_b16 v[208:209], v226 offset:40960
    ds_read_b64_tr_b16 v[210:211], v226 offset:41472
    s_waitcnt lgkmcnt(12)
    v_mfma_f32_32x32x16_bf16 v[176:191], v[56:59], v[216:219], v[176:191]
    ds_read_b64_tr_b16 v[212:213], v226 offset:43008
    ds_read_b64_tr_b16 v[214:215], v226 offset:43520
    s_waitcnt lgkmcnt(12)
    v_mfma_f32_32x32x16_bf16 v[176:191], v[60:63], v[220:223], v[176:191]
    ds_read_b128 v[32:35], v229 offset:4096
    ds_read_b128 v[36:39], v230 offset:4096
    ds_read_b128 v[40:43], v231 offset:4096
    ds_read_b128 v[44:47], v232 offset:4096
    s_waitcnt lgkmcnt(0)
    s_add_u32 s46, s6, 0x280
    s_add_u32 m0, s50, 0x1000
    s_nop 0
    buffer_load_dwordx4 v224, s[8:11], s46 offen lds
    s_add_u32 s46, s6, 0x2280
    s_add_u32 m0, s50, 0x1400
    s_nop 0
    buffer_load_dwordx4 v240, s[8:11], s46 offen lds
    s_add_u32 s46, s6, 0x4280
    s_add_u32 m0, s50, 0x1800
    s_nop 0
    buffer_load_dwordx4 v224, s[8:11], s46 offen lds
    s_add_u32 s46, s6, 0x6280
    s_add_u32 m0, s50, 0x1c00
    s_nop 0
    buffer_load_dwordx4 v240, s[8:11], s46 offen lds
    s_waitcnt vmcnt(11)
    ds_read_b128 v[48:51], v229 offset:8192
    ds_read_b128 v[52:55], v230 offset:8192
    ds_read_b128 v[56:59], v231 offset:8192
    ds_read_b128 v[60:63], v232 offset:8192
    s_waitcnt lgkmcnt(0)
    s_add_u32 s46, s6, 0x300
    s_add_u32 m0, s50, 0x2000
    s_nop 0
    buffer_load_dwordx4 v224, s[8:11], s46 offen lds
    s_add_u32 s46, s6, 0x2300
    s_add_u32 m0, s50, 0x2400
    s_nop 0
    buffer_load_dwordx4 v240, s[8:11], s46 offen lds
    s_add_u32 s46, s6, 0x4300
    s_add_u32 m0, s50, 0x2800
    s_nop 0
    buffer_load_dwordx4 v224, s[8:11], s46 offen lds
    s_add_u32 s46, s6, 0x6300
    s_add_u32 m0, s50, 0x2c00
    s_nop 0
    buffer_load_dwordx4 v240, s[8:11], s46 offen lds
    s_barrier
    s_add_u32 s46, s7, 0x100000
    s_add_u32 m0, s44, 0x4000
    s_nop 0
    buffer_load_dwordx4 v225, s[16:19], s46 offen lds
    s_add_u32 s46, s7, 0x110000
    s_add_u32 m0, s44, 0x4400
    s_nop 0
    buffer_load_dwordx4 v225, s[16:19], s46 offen lds
    s_add_u32 s46, s48, 0x0
    buffer_store_dwordx4 v[136:139], v228, s[28:31], s46 offen offset:1024 sc1
    ds_read_b64_tr_b16 v[216:217], v226 offset:45056
    ds_read_b64_tr_b16 v[218:219], v226 offset:45568
    v_mfma_f32_32x32x16_bf16 v[160:175], v[64:67], v[192:195], v[160:175]
    ds_read_b64_tr_b16 v[220:221], v226 offset:47104
    ds_read_b64_tr_b16 v[222:223], v226 offset:47616
    v_mfma_f32_32x32x16_bf16 v[160:175], v[68:71], v[196:199], v[160:175]
    ds_read_b64_tr_b16 v[192:193], v227 offset:32768
    ds_read_b64_tr_b16 v[194:195], v227 offset:33280
    v_mfma_f32_32x32x16_bf16 v[160:175], v[72:75], v[200:203], v[160:175]
    ds_read_b64_tr_b16 v[196:197], v227 offset:34816
    ds_read_b64_tr_b16 v[198:199], v227 offset:35328
    v_mfma_f32_32x32x16_bf16 v[160:175], v[76:79], v[204:207], v[160:175]
    ds_read_b64_tr_b16 v[200:201], v227 offset:36864
    ds_read_b64_tr_b16 v[202:203], v227 offset:37376
    v_mfma_f32_32x32x16_bf16 v[160:175], v[80:83], v[208:211], v[160:175]
    ds_read_b64_tr_b16 v[204:205], v227 offset:38912
    ds_read_b64_tr_b16 v[206:207], v227 offset:39424
    v_mfma_f32_32x32x16_bf16 v[160:175], v[84:87], v[212:215], v[160:175]
    ds_read_b64_tr_b16 v[208:209], v227 offset:40960
    ds_read_b64_tr_b16 v[210:211], v227 offset:41472
    s_waitcnt lgkmcnt(12)
    v_mfma_f32_32x32x16_bf16 v[160:175], v[88:91], v[216:219], v[160:175]
    ds_read_b64_tr_b16 v[212:213], v227 offset:43008
    ds_read_b64_tr_b16 v[214:215], v227 offset:43520
    s_waitcnt lgkmcnt(12)
    v_mfma_f32_32x32x16_bf16 v[160:175], v[92:95], v[220:223], v[160:175]
    ds_read_b64_tr_b16 v[216:217], v227 offset:45056
    ds_read_b64_tr_b16 v[218:219], v227 offset:45568
    s_waitcnt lgkmcnt(12)
    v_mfma_f32_32x32x16_bf16 v[176:191], v[64:67], v[192:195], v[176:191]
    ds_read_b64_tr_b16 v[220:221], v227 offset:47104
    ds_read_b64_tr_b16 v[222:223], v227 offset:47616
    s_waitcnt lgkmcnt(12)
    v_mfma_f32_32x32x16_bf16 v[176:191], v[68:71], v[196:199], v[176:191]
    ds_read_b64_tr_b16 v[192:193], v226 offset:49152
    ds_read_b64_tr_b16 v[194:195], v226 offset:49664
    s_waitcnt lgkmcnt(12)
    v_mfma_f32_32x32x16_bf16 v[176:191], v[72:75], v[200:203], v[176:191]
    ds_read_b64_tr_b16 v[196:197], v226 offset:51200
    ds_read_b64_tr_b16 v[198:199], v226 offset:51712
    s_waitcnt lgkmcnt(12)
    v_mfma_f32_32x32x16_bf16 v[176:191], v[76:79], v[204:207], v[176:191]
    ds_read_b64_tr_b16 v[200:201], v226 offset:53248
    ds_read_b64_tr_b16 v[202:203], v226 offset:53760
    s_waitcnt lgkmcnt(12)
    v_mfma_f32_32x32x16_bf16 v[176:191], v[80:83], v[208:211], v[176:191]
    ds_read_b64_tr_b16 v[204:205], v226 offset:55296
    ds_read_b64_tr_b16 v[206:207], v226 offset:55808
    s_waitcnt lgkmcnt(12)
    v_mfma_f32_32x32x16_bf16 v[176:191], v[84:87], v[212:215], v[176:191]
    ds_read_b64_tr_b16 v[208:209], v226 offset:57344
    ds_read_b64_tr_b16 v[210:211], v226 offset:57856
    s_waitcnt lgkmcnt(12)
    v_mfma_f32_32x32x16_bf16 v[176:191], v[88:91], v[216:219], v[176:191]
    ds_read_b64_tr_b16 v[212:213], v226 offset:59392
    ds_read_b64_tr_b16 v[214:215], v226 offset:59904
    s_waitcnt lgkmcnt(12)
    v_mfma_f32_32x32x16_bf16 v[176:191], v[92:95], v[220:223], v[176:191]
    s_waitcnt vmcnt(14)
    ds_read_b128 v[64:67], v229 offset:0
    ds_read_b128 v[68:71], v230 offset:0
    ds_read_b128 v[72:75], v231 offset:0
    ds_read_b128 v[76:79], v232 offset:0
    s_waitcnt lgkmcnt(0)
    s_add_u32 s46, s6, 0x380
    s_add_u32 m0, s50, 0x0
    s_nop 0
    buffer_load_dwordx4 v224, s[8:11], s46 offen lds
    s_add_u32 s46, s6, 0x2380
    s_add_u32 m0, s50, 0x400
    s_nop 0
    buffer_load_dwordx4 v240, s[8:11], s46 offen lds
    s_add_u32 s46, s6, 0x4380
    s_add_u32 m0, s50, 0x800
    s_nop 0
    buffer_load_dwordx4 v224, s[8:11], s46 offen lds
    s_add_u32 s46, s6, 0x6380
    s_add_u32 m0, s50, 0xc00
    s_nop 0
    buffer_load_dwordx4 v240, s[8:11], s46 offen lds
    s_waitcnt vmcnt(11)
    ds_read_b128 v[80:83], v229 offset:4096
    ds_read_b128 v[84:87], v230 offset:4096
    ds_read_b128 v[88:91], v231 offset:4096
    ds_read_b128 v[92:95], v232 offset:4096
    s_barrier
    s_add_u32 s46, s7, 0x200000
    s_add_u32 m0, s44, 0x8000
    s_nop 0
    buffer_load_dwordx4 v225, s[16:19], s46 offen lds
    s_add_u32 s46, s7, 0x210000
    s_add_u32 m0, s44, 0x8400
    s_nop 0
    buffer_load_dwordx4 v225, s[16:19], s46 offen lds
    s_add_u32 s46, s48, 0x1000
    buffer_store_dwordx4 v[144:147], v228, s[28:31], s46 offen offset:0 sc1
    s_add_u32 s46, s48, 0x1000
    buffer_store_dwordx4 v[152:155], v228, s[28:31], s46 offen offset:1024 sc1
    ds_read_b64_tr_b16 v[216:217], v226 offset:61440
    ds_read_b64_tr_b16 v[218:219], v226 offset:61952
    v_mfma_f32_32x32x16_bf16 v[160:175], v[96:99], v[192:195], v[160:175]
    ds_read_b64_tr_b16 v[220:221], v226 offset:63488
    ds_read_b64_tr_b16 v[222:223], v226 offset:64000
    v_mfma_f32_32x32x16_bf16 v[160:175], v[100:103], v[196:199], v[160:175]
    ds_read_b64_tr_b16 v[192:193], v227 offset:49152
    ds_read_b64_tr_b16 v[194:195], v227 offset:49664
    v_mfma_f32_32x32x16_bf16 v[160:175], v[104:107], v[200:203], v[160:175]
    ds_read_b64_tr_b16 v[196:197], v227 offset:51200
    ds_read_b64_tr_b16 v[198:199], v227 offset:51712
    v_mfma_f32_32x32x16_bf16 v[160:175], v[108:111], v[204:207], v[160:175]
    ds_read_b64_tr_b16 v[200:201], v227 offset:53248
    ds_read_b64_tr_b16 v[202:203], v227 offset:53760
    v_mfma_f32_32x32x16_bf16 v[160:175], v[112:115], v[208:211], v[160:175]
    ds_read_b64_tr_b16 v[204:205], v227 offset:55296
    ds_read_b64_tr_b16 v[206:207], v227 offset:55808
    v_mfma_f32_32x32x16_bf16 v[160:175], v[116:119], v[212:215], v[160:175]
    ds_read_b64_tr_b16 v[208:209], v227 offset:57344
    ds_read_b64_tr_b16 v[210:211], v227 offset:57856
    s_waitcnt lgkmcnt(12)
    v_mfma_f32_32x32x16_bf16 v[160:175], v[120:123], v[216:219], v[160:175]
    ds_read_b64_tr_b16 v[212:213], v227 offset:59392
    ds_read_b64_tr_b16 v[214:215], v227 offset:59904
    s_waitcnt lgkmcnt(12)
    v_mfma_f32_32x32x16_bf16 v[160:175], v[124:127], v[220:223], v[160:175]
    ds_read_b64_tr_b16 v[216:217], v227 offset:61440
    ds_read_b64_tr_b16 v[218:219], v227 offset:61952
    s_waitcnt lgkmcnt(12)
    v_mfma_f32_32x32x16_bf16 v[176:191], v[96:99], v[192:195], v[176:191]
    ds_read_b64_tr_b16 v[220:221], v227 offset:63488
    ds_read_b64_tr_b16 v[222:223], v227 offset:64000
    s_waitcnt lgkmcnt(12)
    v_mfma_f32_32x32x16_bf16 v[176:191], v[100:103], v[196:199], v[176:191]
    ds_read_b64_tr_b16 v[192:193], v226 offset:0
    ds_read_b64_tr_b16 v[194:195], v226 offset:512
    s_waitcnt lgkmcnt(12)
    v_mfma_f32_32x32x16_bf16 v[176:191], v[104:107], v[200:203], v[176:191]
    ds_read_b64_tr_b16 v[196:197], v226 offset:2048
    ds_read_b64_tr_b16 v[198:199], v226 offset:2560
    s_waitcnt lgkmcnt(12)
    v_mfma_f32_32x32x16_bf16 v[176:191], v[108:111], v[204:207], v[176:191]
    v_cvt_pk_bf16_f32 v160, v160, v161
    v_cvt_pk_bf16_f32 v161, v162, v163
    v_cvt_pk_bf16_f32 v162, v164, v165
    v_cvt_pk_bf16_f32 v163, v166, v167
    v_cvt_pk_bf16_f32 v168, v168, v169
    v_cvt_pk_bf16_f32 v169, v170, v171
    v_cvt_pk_bf16_f32 v170, v172, v173
    v_cvt_pk_bf16_f32 v171, v174, v175
    ds_read_b64_tr_b16 v[200:201], v226 offset:4096
    ds_read_b64_tr_b16 v[202:203], v226 offset:4608
    s_waitcnt lgkmcnt(12)
    v_mfma_f32_32x32x16_bf16 v[176:191], v[112:115], v[208:211], v[176:191]
    ds_read_b64_tr_b16 v[204:205], v226 offset:6144
    ds_read_b64_tr_b16 v[206:207], v226 offset:6656
    s_waitcnt lgkmcnt(12)
    v_mfma_f32_32x32x16_bf16 v[176:191], v[116:119], v[212:215], v[176:191]
    ds_read_b64_tr_b16 v[208:209], v226 offset:8192
    ds_read_b64_tr_b16 v[210:211], v226 offset:8704
    s_waitcnt lgkmcnt(12)
    v_mfma_f32_32x32x16_bf16 v[176:191], v[120:123], v[216:219], v[176:191]
    ds_read_b64_tr_b16 v[212:213], v226 offset:10240
    ds_read_b64_tr_b16 v[214:215], v226 offset:10752
    s_waitcnt lgkmcnt(12)
    v_mfma_f32_32x32x16_bf16 v[176:191], v[124:127], v[220:223], v[176:191]
    s_waitcnt vmcnt(11)
    ds_read_b128 v[96:99], v229 offset:8192
    ds_read_b128 v[100:103], v230 offset:8192
    ds_read_b128 v[104:107], v231 offset:8192
    ds_read_b128 v[108:111], v232 offset:8192
    s_waitcnt vmcnt(4)
    ds_read_b128 v[112:115], v229 offset:0
    ds_read_b128 v[116:119], v230 offset:0
    ds_read_b128 v[120:123], v231 offset:0
    ds_read_b128 v[124:127], v232 offset:0
    s_barrier
    s_add_u32 s46, s7, 0x300000
    s_add_u32 m0, s44, 0xc000
    s_nop 0
    buffer_load_dwordx4 v225, s[16:19], s46 offen lds
    s_add_u32 s46, s7, 0x310000
    s_add_u32 m0, s44, 0xc400
    s_nop 0
    buffer_load_dwordx4 v225, s[16:19], s46 offen lds
    ds_read_b64_tr_b16 v[216:217], v226 offset:12288
    ds_read_b64_tr_b16 v[218:219], v226 offset:12800
    s_waitcnt lgkmcnt(15)
    v_mfma_f32_32x32x16_bf16 v[128:143], v[192:195], v[0:3], 0
    ds_read_b64_tr_b16 v[220:221], v226 offset:14336
    ds_read_b64_tr_b16 v[222:223], v226 offset:14848
    v_mfma_f32_32x32x16_bf16 v[128:143], v[196:199], v[4:7], v[128:143]
    ds_read_b64_tr_b16 v[192:193], v227 offset:0
    ds_read_b64_tr_b16 v[194:195], v227 offset:512
    v_mfma_f32_32x32x16_bf16 v[128:143], v[200:203], v[8:11], v[128:143]
    ds_read_b64_tr_b16 v[196:197], v227 offset:2048
    ds_read_b64_tr_b16 v[198:199], v227 offset:2560
    s_waitcnt lgkmcnt(15)
    v_mfma_f32_32x32x16_bf16 v[128:143], v[204:207], v[12:15], v[128:143]
    v_cvt_pk_bf16_f32 v176, v176, v177
    v_cvt_pk_bf16_f32 v177, v178, v179
    v_cvt_pk_bf16_f32 v178, v180, v181
    v_cvt_pk_bf16_f32 v179, v182, v183
    v_cvt_pk_bf16_f32 v184, v184, v185
    v_cvt_pk_bf16_f32 v185, v186, v187
    v_cvt_pk_bf16_f32 v186, v188, v189
    v_cvt_pk_bf16_f32 v187, v190, v191
    ds_read_b64_tr_b16 v[200:201], v227 offset:4096
    ds_read_b64_tr_b16 v[202:203], v227 offset:4608
    v_mfma_f32_32x32x16_bf16 v[128:143], v[208:211], v[16:19], v[128:143]
    ds_read_b64_tr_b16 v[204:205], v227 offset:6144
    ds_read_b64_tr_b16 v[206:207], v227 offset:6656
    v_mfma_f32_32x32x16_bf16 v[128:143], v[212:215], v[20:23], v[128:143]
    ds_read_b64_tr_b16 v[208:209], v227 offset:8192
    ds_read_b64_tr_b16 v[210:211], v227 offset:8704
    s_waitcnt lgkmcnt(12)
    v_mfma_f32_32x32x16_bf16 v[128:143], v[216:219], v[24:27], v[128:143]
    ds_read_b64_tr_b16 v[212:213], v227 offset:10240
    ds_read_b64_tr_b16 v[214:215], v227 offset:10752
    s_waitcnt lgkmcnt(12)
    v_mfma_f32_32x32x16_bf16 v[128:143], v[220:223], v[28:31], v[128:143]
    ds_read_b64_tr_b16 v[216:217], v227 offset:12288
    ds_read_b64_tr_b16 v[218:219], v227 offset:12800
    s_waitcnt lgkmcnt(12)
    v_mfma_f32_32x32x16_bf16 v[144:159], v[192:195], v[0:3], 0
    ds_read_b64_tr_b16 v[220:221], v227 offset:14336
    ds_read_b64_tr_b16 v[222:223], v227 offset:14848
    s_waitcnt lgkmcnt(12)
    v_mfma_f32_32x32x16_bf16 v[144:159], v[196:199], v[4:7], v[144:159]
    ds_read_b64_tr_b16 v[192:193], v226 offset:16384
    ds_read_b64_tr_b16 v[194:195], v226 offset:16896
    s_waitcnt lgkmcnt(12)
    v_mfma_f32_32x32x16_bf16 v[144:159], v[200:203], v[8:11], v[144:159]
    ds_read_b64_tr_b16 v[196:197], v226 offset:18432
    ds_read_b64_tr_b16 v[198:199], v226 offset:18944
    s_waitcnt lgkmcnt(12)
    v_mfma_f32_32x32x16_bf16 v[144:159], v[204:207], v[12:15], v[144:159]
    ds_read_b64_tr_b16 v[200:201], v226 offset:20480
    ds_read_b64_tr_b16 v[202:203], v226 offset:20992
    s_waitcnt lgkmcnt(12)
    v_mfma_f32_32x32x16_bf16 v[144:159], v[208:211], v[16:19], v[144:159]
    ds_read_b64_tr_b16 v[204:205], v226 offset:22528
    ds_read_b64_tr_b16 v[206:207], v226 offset:23040
    s_waitcnt lgkmcnt(12)
    v_mfma_f32_32x32x16_bf16 v[144:159], v[212:215], v[20:23], v[144:159]
    ds_read_b64_tr_b16 v[208:209], v226 offset:24576
    ds_read_b64_tr_b16 v[210:211], v226 offset:25088
    s_waitcnt lgkmcnt(12)
    v_mfma_f32_32x32x16_bf16 v[144:159], v[216:219], v[24:27], v[144:159]
    ds_read_b64_tr_b16 v[212:213], v226 offset:26624
    ds_read_b64_tr_b16 v[214:215], v226 offset:27136
    s_waitcnt lgkmcnt(12)
    v_mfma_f32_32x32x16_bf16 v[144:159], v[220:223], v[28:31], v[144:159]
    v_lshrrev_b32 v242, 13, v225
    v_and_b32 v243, 0x7f, v225
    v_lshl_add_u32 v242, v242, 10, v243
    s_lshl_b32 s51, s2, 14
    s_lshl_b32 s46, s3, 7
    s_add_u32 s51, s51, s46
    s_add_u32 s46, s51, 0
    s_add_u32 m0, s50, 0
    s_nop 0
    buffer_load_dwordx4 v242, s[56:59], s46 offen lds
    s_add_u32 s46, s51, 8192
    s_add_u32 m0, s50, 1024
    s_nop 0
    buffer_load_dwordx4 v242, s[56:59], s46 offen lds
    s_waitcnt vmcnt(6)
    s_barrier
    s_add_u32 s46, s7, 0x80
    s_add_u32 m0, s44, 0x0
    s_nop 0
    buffer_load_dwordx4 v225, s[16:19], s46 offen lds
    s_add_u32 s46, s7, 0x10080
    s_add_u32 m0, s44, 0x400
    s_nop 0
    buffer_load_dwordx4 v225, s[16:19], s46 offen lds
    s_add_u32 s46, s48, 0x2000
    buffer_store_dwordx4 v[160:163], v228, s[28:31], s46 offen offset:0 sc1
    ds_read_b64_tr_b16 v[216:217], v226 offset:28672
    ds_read_b64_tr_b16 v[218:219], v226 offset:29184
    s_waitcnt lgkmcnt(12)
    v_mfma_f32_32x32x16_bf16 v[128:143], v[192:195], v[32:35], v[128:143]
    ds_read_b64_tr_b16 v[220:221], v226 offset:30720
    ds_read_b64_tr_b16 v[222:223], v226 offset:31232
    s_waitcnt lgkmcnt(12)
    v_mfma_f32_32x32x16_bf16 v[128:143], v[196:199], v[36:39], v[128:143]
    ds_read_b64_tr_b16 v[192:193], v227 offset:16384
    ds_read_b64_tr_b16 v[194:195], v227 offset:16896
    s_waitcnt lgkmcnt(12)
    v_mfma_f32_32x32x16_bf16 v[128:143], v[200:203], v[40:43], v[128:143]
    ds_read_b64_tr_b16 v[196:197], v227 offset:18432
    ds_read_b64_tr_b16 v[198:199], v227 offset:18944
    s_waitcnt lgkmcnt(12)
    v_mfma_f32_32x32x16_bf16 v[128:143], v[204:207], v[44:47], v[128:143]
    ds_read_b64_tr_b16 v[200:201], v227 offset:20480
    ds_read_b64_tr_b16 v[202:203], v227 offset:20992
    s_waitcnt lgkmcnt(12)
    v_mfma_f32_32x32x16_bf16 v[128:143], v[208:211], v[48:51], v[128:143]
    ds_read_b64_tr_b16 v[204:205], v227 offset:22528
    ds_read_b64_tr_b16 v[206:207], v227 offset:23040
    s_waitcnt lgkmcnt(12)
    v_mfma_f32_32x32x16_bf16 v[128:143], v[212:215], v[52:55], v[128:143]
    ds_read_b64_tr_b16 v[208:209], v227 offset:24576
    ds_read_b64_tr_b16 v[210:211], v227 offset:25088
    s_waitcnt lgkmcnt(12)
    v_mfma_f32_32x32x16_bf16 v[128:143], v[216:219], v[56:59], v[128:143]
    ds_read_b64_tr_b16 v[212:213], v227 offset:26624
    ds_read_b64_tr_b16 v[214:215], v227 offset:27136
    s_waitcnt lgkmcnt(12)
    v_mfma_f32_32x32x16_bf16 v[128:143], v[220:223], v[60:63], v[128:143]
    ds_read_b64_tr_b16 v[216:217], v227 offset:28672
    ds_read_b64_tr_b16 v[218:219], v227 offset:29184
    s_waitcnt lgkmcnt(12)
    v_mfma_f32_32x32x16_bf16 v[144:159], v[192:195], v[32:35], v[144:159]
    ds_read_b64_tr_b16 v[220:221], v227 offset:30720
    ds_read_b64_tr_b16 v[222:223], v227 offset:31232
    s_waitcnt lgkmcnt(12)
    v_mfma_f32_32x32x16_bf16 v[144:159], v[196:199], v[36:39], v[144:159]
    ds_read_b64_tr_b16 v[192:193], v226 offset:32768
    ds_read_b64_tr_b16 v[194:195], v226 offset:33280
    s_waitcnt lgkmcnt(12)
    v_mfma_f32_32x32x16_bf16 v[144:159], v[200:203], v[40:43], v[144:159]
    ds_read_b64_tr_b16 v[196:197], v226 offset:34816
    ds_read_b64_tr_b16 v[198:199], v226 offset:35328
    s_waitcnt lgkmcnt(12)
    v_mfma_f32_32x32x16_bf16 v[144:159], v[204:207], v[44:47], v[144:159]
    ds_read_b64_tr_b16 v[200:201], v226 offset:36864
    ds_read_b64_tr_b16 v[202:203], v226 offset:37376
    s_waitcnt lgkmcnt(12)
    v_mfma_f32_32x32x16_bf16 v[144:159], v[208:211], v[48:51], v[144:159]
    ds_read_b64_tr_b16 v[204:205], v226 offset:38912
    ds_read_b64_tr_b16 v[206:207], v226 offset:39424
    s_waitcnt lgkmcnt(12)
    v_mfma_f32_32x32x16_bf16 v[144:159], v[212:215], v[52:55], v[144:159]
    ds_read_b64_tr_b16 v[208:209], v226 offset:40960
    ds_read_b64_tr_b16 v[210:211], v226 offset:41472
    s_waitcnt lgkmcnt(12)
    v_mfma_f32_32x32x16_bf16 v[144:159], v[216:219], v[56:59], v[144:159]
    ds_read_b64_tr_b16 v[212:213], v226 offset:43008
    ds_read_b64_tr_b16 v[214:215], v226 offset:43520
    s_waitcnt lgkmcnt(12)
    v_mfma_f32_32x32x16_bf16 v[144:159], v[220:223], v[60:63], v[144:159]
    v_lshrrev_b32 v241, 7, v228
    v_and_b32 v243, 0x70, v228
    v_lshl_add_u32 v241, v241, 10, v243
    s_lshr_b32 s51, s2, 3
    s_lshl_b32 s51, s51, 16
    s_lshl_b32 s46, s3, 13
    s_add_u32 s51, s51, s46
    s_and_b32 s46, s2, 7
    s_lshl_b32 s46, s46, 7
    s_add_u32 s51, s51, s46
    s_add_u32 m0, s50, 4096
    s_nop 0
    buffer_load_dwordx4 v241, s[60:63], s51 offen lds
    s_waitcnt vmcnt(6)
    s_barrier
    s_add_u32 s46, s7, 0x100080
    s_add_u32 m0, s44, 0x4000
    s_nop 0
    buffer_load_dwordx4 v225, s[16:19], s46 offen lds
    s_add_u32 s46, s7, 0x110080
    s_add_u32 m0, s44, 0x4400
    s_nop 0
    buffer_load_dwordx4 v225, s[16:19], s46 offen lds
    s_add_u32 s46, s48, 0x2000
    buffer_store_dwordx4 v[168:171], v228, s[28:31], s46 offen offset:1024 sc1
    ds_read_b64_tr_b16 v[216:217], v226 offset:45056
    ds_read_b64_tr_b16 v[218:219], v226 offset:45568
    s_waitcnt lgkmcnt(12)
    v_mfma_f32_32x32x16_bf16 v[128:143], v[192:195], v[64:67], v[128:143]
    ds_read_b64_tr_b16 v[220:221], v226 offset:47104
    ds_read_b64_tr_b16 v[222:223], v226 offset:47616
    s_waitcnt lgkmcnt(12)
    v_mfma_f32_32x32x16_bf16 v[128:143], v[196:199], v[68:71], v[128:143]
    ds_read_b64_tr_b16 v[192:193], v227 offset:32768
    ds_read_b64_tr_b16 v[194:195], v227 offset:33280
    s_waitcnt lgkmcnt(12)
    v_mfma_f32_32x32x16_bf16 v[128:143], v[200:203], v[72:75], v[128:143]
    ds_read_b64_tr_b16 v[196:197], v227 offset:34816
    ds_read_b64_tr_b16 v[198:199], v227 offset:35328
    s_waitcnt lgkmcnt(12)
    v_mfma_f32_32x32x16_bf16 v[128:143], v[204:207], v[76:79], v[128:143]
    ds_read_b64_tr_b16 v[200:201], v227 offset:36864
    ds_read_b64_tr_b16 v[202:203], v227 offset:37376
    s_waitcnt lgkmcnt(12)
    v_mfma_f32_32x32x16_bf16 v[128:143], v[208:211], v[80:83], v[128:143]
    ds_read_b64_tr_b16 v[204:205], v227 offset:38912
    ds_read_b64_tr_b16 v[206:207], v227 offset:39424
    s_waitcnt lgkmcnt(12)
    v_mfma_f32_32x32x16_bf16 v[128:143], v[212:215], v[84:87], v[128:143]
    ds_read_b64_tr_b16 v[208:209], v227 offset:40960
    ds_read_b64_tr_b16 v[210:211], v227 offset:41472
    s_waitcnt lgkmcnt(12)
    v_mfma_f32_32x32x16_bf16 v[128:143], v[216:219], v[88:91], v[128:143]
    ds_read_b64_tr_b16 v[212:213], v227 offset:43008
    ds_read_b64_tr_b16 v[214:215], v227 offset:43520
    s_waitcnt lgkmcnt(12)
    v_mfma_f32_32x32x16_bf16 v[128:143], v[220:223], v[92:95], v[128:143]
    ds_read_b64_tr_b16 v[216:217], v227 offset:45056
    ds_read_b64_tr_b16 v[218:219], v227 offset:45568
    s_waitcnt lgkmcnt(12)
    v_mfma_f32_32x32x16_bf16 v[144:159], v[192:195], v[64:67], v[144:159]
    ds_read_b64_tr_b16 v[220:221], v227 offset:47104
    ds_read_b64_tr_b16 v[222:223], v227 offset:47616
    s_waitcnt lgkmcnt(12)
    v_mfma_f32_32x32x16_bf16 v[144:159], v[196:199], v[68:71], v[144:159]
    ds_read_b64_tr_b16 v[192:193], v226 offset:49152
    ds_read_b64_tr_b16 v[194:195], v226 offset:49664
    s_waitcnt lgkmcnt(12)
    v_mfma_f32_32x32x16_bf16 v[144:159], v[200:203], v[72:75], v[144:159]
    ds_read_b64_tr_b16 v[196:197], v226 offset:51200
    ds_read_b64_tr_b16 v[198:199], v226 offset:51712
    s_waitcnt lgkmcnt(12)
    v_mfma_f32_32x32x16_bf16 v[144:159], v[204:207], v[76:79], v[144:159]
    ds_read_b64_tr_b16 v[200:201], v226 offset:53248
    ds_read_b64_tr_b16 v[202:203], v226 offset:53760
    s_waitcnt lgkmcnt(12)
    v_mfma_f32_32x32x16_bf16 v[144:159], v[208:211], v[80:83], v[144:159]
    ds_read_b64_tr_b16 v[204:205], v226 offset:55296
    ds_read_b64_tr_b16 v[206:207], v226 offset:55808
    s_waitcnt lgkmcnt(12)
    v_mfma_f32_32x32x16_bf16 v[144:159], v[212:215], v[84:87], v[144:159]
    ds_read_b64_tr_b16 v[208:209], v226 offset:57344
    ds_read_b64_tr_b16 v[210:211], v226 offset:57856
    s_waitcnt lgkmcnt(12)
    v_mfma_f32_32x32x16_bf16 v[144:159], v[216:219], v[88:91], v[144:159]
    ds_read_b64_tr_b16 v[212:213], v226 offset:59392
    ds_read_b64_tr_b16 v[214:215], v226 offset:59904
    s_waitcnt lgkmcnt(12)
    v_mfma_f32_32x32x16_bf16 v[144:159], v[220:223], v[92:95], v[144:159]
    s_waitcnt vmcnt(5)
    s_barrier
    s_add_u32 s46, s7, 0x200080
    s_add_u32 m0, s44, 0x8000
    s_nop 0
    buffer_load_dwordx4 v225, s[16:19], s46 offen lds
    s_add_u32 s46, s7, 0x210080
    s_add_u32 m0, s44, 0x8400
    s_nop 0
    buffer_load_dwordx4 v225, s[16:19], s46 offen lds
    s_add_u32 s46, s48, 0x3000
    buffer_store_dwordx4 v[176:179], v228, s[28:31], s46 offen offset:0 sc1
    s_add_u32 s46, s48, 0x3000
    buffer_store_dwordx4 v[184:187], v228, s[28:31], s46 offen offset:1024 sc1
    ds_read_b64_tr_b16 v[216:217], v226 offset:61440
    ds_read_b64_tr_b16 v[218:219], v226 offset:61952
    s_waitcnt lgkmcnt(12)
    v_mfma_f32_32x32x16_bf16 v[128:143], v[192:195], v[96:99], v[128:143]
    ds_read_b64_tr_b16 v[220:221], v226 offset:63488
    ds_read_b64_tr_b16 v[222:223], v226 offset:64000
    s_waitcnt lgkmcnt(12)
    v_mfma_f32_32x32x16_bf16 v[128:143], v[196:199], v[100:103], v[128:143]
    ds_read_b64_tr_b16 v[192:193], v227 offset:49152
    ds_read_b64_tr_b16 v[194:195], v227 offset:49664
    s_waitcnt lgkmcnt(12)
    v_mfma_f32_32x32x16_bf16 v[128:143], v[200:203], v[104:107], v[128:143]
    ds_read_b64_tr_b16 v[196:197], v227 offset:51200
    ds_read_b64_tr_b16 v[198:199], v227 offset:51712
    s_waitcnt lgkmcnt(12)
    v_mfma_f32_32x32x16_bf16 v[128:143], v[204:207], v[108:111], v[128:143]
    ds_read_b64_tr_b16 v[200:201], v227 offset:53248
    ds_read_b64_tr_b16 v[202:203], v227 offset:53760
    s_waitcnt lgkmcnt(12)
    v_mfma_f32_32x32x16_bf16 v[128:143], v[208:211], v[112:115], v[128:143]
    ds_read_b64_tr_b16 v[204:205], v227 offset:55296
    ds_read_b64_tr_b16 v[206:207], v227 offset:55808
    s_waitcnt lgkmcnt(12)
    v_mfma_f32_32x32x16_bf16 v[128:143], v[212:215], v[116:119], v[128:143]
    ds_read_b64_tr_b16 v[208:209], v227 offset:57344
    ds_read_b64_tr_b16 v[210:211], v227 offset:57856
    s_waitcnt lgkmcnt(12)
    v_mfma_f32_32x32x16_bf16 v[128:143], v[216:219], v[120:123], v[128:143]
    ds_read_b64_tr_b16 v[212:213], v227 offset:59392
    ds_read_b64_tr_b16 v[214:215], v227 offset:59904
    s_waitcnt lgkmcnt(12)
    v_mfma_f32_32x32x16_bf16 v[128:143], v[220:223], v[124:127], v[128:143]
    ds_read_b64_tr_b16 v[216:217], v227 offset:61440
    ds_read_b64_tr_b16 v[218:219], v227 offset:61952
    s_waitcnt lgkmcnt(12)
    v_mfma_f32_32x32x16_bf16 v[144:159], v[192:195], v[96:99], v[144:159]
    ds_read_b64_tr_b16 v[220:221], v227 offset:63488
    ds_read_b64_tr_b16 v[222:223], v227 offset:64000
    s_waitcnt lgkmcnt(12)
    v_mfma_f32_32x32x16_bf16 v[144:159], v[196:199], v[100:103], v[144:159]
    ds_read_b64_tr_b16 v[192:193], v226 offset:0
    ds_read_b64_tr_b16 v[194:195], v226 offset:512
    s_waitcnt lgkmcnt(12)
    v_mfma_f32_32x32x16_bf16 v[144:159], v[200:203], v[104:107], v[144:159]
    ds_read_b64_tr_b16 v[196:197], v226 offset:2048
    ds_read_b64_tr_b16 v[198:199], v226 offset:2560
    s_waitcnt lgkmcnt(12)
    v_mfma_f32_32x32x16_bf16 v[144:159], v[204:207], v[108:111], v[144:159]
    v_mul_f32 v128, s49, v128
    v_mul_f32 v129, s49, v129
    v_mul_f32 v130, s49, v130
    v_mul_f32 v131, s49, v131
    v_mul_f32 v132, s49, v132
    v_mul_f32 v133, s49, v133
    v_mul_f32 v134, s49, v134
    v_mul_f32 v135, s49, v135
    v_mul_f32 v136, s49, v136
    v_mul_f32 v137, s49, v137
    v_mul_f32 v138, s49, v138
    v_mul_f32 v139, s49, v139
    v_mul_f32 v140, s49, v140
    v_mul_f32 v141, s49, v141
    v_mul_f32 v142, s49, v142
    v_mul_f32 v143, s49, v143
    v_cvt_pk_bf16_f32 v128, v128, v129
    v_cvt_pk_bf16_f32 v129, v130, v131
    v_cvt_pk_bf16_f32 v130, v132, v133
    v_cvt_pk_bf16_f32 v131, v134, v135
    v_cvt_pk_bf16_f32 v136, v136, v137
    v_cvt_pk_bf16_f32 v137, v138, v139
    v_cvt_pk_bf16_f32 v138, v140, v141
    v_cvt_pk_bf16_f32 v139, v142, v143
    ds_read_b64_tr_b16 v[200:201], v226 offset:4096
    ds_read_b64_tr_b16 v[202:203], v226 offset:4608
    s_waitcnt lgkmcnt(12)
    v_mfma_f32_32x32x16_bf16 v[144:159], v[208:211], v[112:115], v[144:159]
    ds_read_b64_tr_b16 v[204:205], v226 offset:6144
    ds_read_b64_tr_b16 v[206:207], v226 offset:6656
    s_waitcnt lgkmcnt(12)
    v_mfma_f32_32x32x16_bf16 v[144:159], v[212:215], v[116:119], v[144:159]
    ds_read_b64_tr_b16 v[208:209], v226 offset:8192
    ds_read_b64_tr_b16 v[210:211], v226 offset:8704
    s_waitcnt lgkmcnt(12)
    v_mfma_f32_32x32x16_bf16 v[144:159], v[216:219], v[120:123], v[144:159]
    ds_read_b64_tr_b16 v[212:213], v226 offset:10240
    ds_read_b64_tr_b16 v[214:215], v226 offset:10752
    s_waitcnt lgkmcnt(12)
    v_mfma_f32_32x32x16_bf16 v[144:159], v[220:223], v[124:127], v[144:159]
    s_waitcnt vmcnt(7)
    s_waitcnt vmcnt(5)
    s_barrier
    s_add_u32 s46, s7, 0x300080
    s_add_u32 m0, s44, 0xc000
    s_nop 0
    buffer_load_dwordx4 v225, s[16:19], s46 offen lds
    s_add_u32 s46, s7, 0x310080
    s_add_u32 m0, s44, 0xc400
    s_nop 0
    buffer_load_dwordx4 v225, s[16:19], s46 offen lds
    ds_read_b64_tr_b16 v[216:217], v226 offset:12288
    ds_read_b64_tr_b16 v[218:219], v226 offset:12800
    s_waitcnt lgkmcnt(12)
    v_mfma_f32_32x32x16_bf16 v[160:175], v[192:195], v[0:3], 0
    ds_read_b64_tr_b16 v[220:221], v226 offset:14336
    ds_read_b64_tr_b16 v[222:223], v226 offset:14848
    s_waitcnt lgkmcnt(12)
    v_mfma_f32_32x32x16_bf16 v[160:175], v[196:199], v[4:7], v[160:175]
    ds_read_b64_tr_b16 v[192:193], v227 offset:0
    ds_read_b64_tr_b16 v[194:195], v227 offset:512
    s_waitcnt lgkmcnt(12)
    v_mfma_f32_32x32x16_bf16 v[160:175], v[200:203], v[8:11], v[160:175]
    ds_read_b64_tr_b16 v[196:197], v227 offset:2048
    ds_read_b64_tr_b16 v[198:199], v227 offset:2560
    s_waitcnt lgkmcnt(12)
    v_mfma_f32_32x32x16_bf16 v[160:175], v[204:207], v[12:15], v[160:175]
    v_mul_f32 v144, s49, v144
    v_mul_f32 v145, s49, v145
    v_mul_f32 v146, s49, v146
    v_mul_f32 v147, s49, v147
    v_mul_f32 v148, s49, v148
    v_mul_f32 v149, s49, v149
    v_mul_f32 v150, s49, v150
    v_mul_f32 v151, s49, v151
    v_mul_f32 v152, s49, v152
    v_mul_f32 v153, s49, v153
    v_mul_f32 v154, s49, v154
    v_mul_f32 v155, s49, v155
    v_mul_f32 v156, s49, v156
    v_mul_f32 v157, s49, v157
    v_mul_f32 v158, s49, v158
    v_mul_f32 v159, s49, v159
    v_cvt_pk_bf16_f32 v144, v144, v145
    v_cvt_pk_bf16_f32 v145, v146, v147
    v_cvt_pk_bf16_f32 v146, v148, v149
    v_cvt_pk_bf16_f32 v147, v150, v151
    v_cvt_pk_bf16_f32 v152, v152, v153
    v_cvt_pk_bf16_f32 v153, v154, v155
    v_cvt_pk_bf16_f32 v154, v156, v157
    v_cvt_pk_bf16_f32 v155, v158, v159
    ds_read_b64_tr_b16 v[200:201], v227 offset:4096
    ds_read_b64_tr_b16 v[202:203], v227 offset:4608
    s_waitcnt lgkmcnt(12)
    v_mfma_f32_32x32x16_bf16 v[160:175], v[208:211], v[16:19], v[160:175]
    ds_read_b64_tr_b16 v[204:205], v227 offset:6144
    ds_read_b64_tr_b16 v[206:207], v227 offset:6656
    s_waitcnt lgkmcnt(12)
    v_mfma_f32_32x32x16_bf16 v[160:175], v[212:215], v[20:23], v[160:175]
    ds_read_b64_tr_b16 v[208:209], v227 offset:8192
    ds_read_b64_tr_b16 v[210:211], v227 offset:8704
    s_waitcnt lgkmcnt(12)
    v_mfma_f32_32x32x16_bf16 v[160:175], v[216:219], v[24:27], v[160:175]
    ds_read_b64_tr_b16 v[212:213], v227 offset:10240
    ds_read_b64_tr_b16 v[214:215], v227 offset:10752
    s_waitcnt lgkmcnt(12)
    v_mfma_f32_32x32x16_bf16 v[160:175], v[220:223], v[28:31], v[160:175]
    ds_read_b64_tr_b16 v[216:217], v227 offset:12288
    ds_read_b64_tr_b16 v[218:219], v227 offset:12800
    s_waitcnt lgkmcnt(12)
    v_mfma_f32_32x32x16_bf16 v[176:191], v[192:195], v[0:3], 0
    ds_read_b64_tr_b16 v[220:221], v227 offset:14336
    ds_read_b64_tr_b16 v[222:223], v227 offset:14848
    s_waitcnt lgkmcnt(12)
    v_mfma_f32_32x32x16_bf16 v[176:191], v[196:199], v[4:7], v[176:191]
    ds_read_b64_tr_b16 v[192:193], v226 offset:16384
    ds_read_b64_tr_b16 v[194:195], v226 offset:16896
    s_waitcnt lgkmcnt(12)
    v_mfma_f32_32x32x16_bf16 v[176:191], v[200:203], v[8:11], v[176:191]
    ds_read_b64_tr_b16 v[196:197], v226 offset:18432
    ds_read_b64_tr_b16 v[198:199], v226 offset:18944
    s_waitcnt lgkmcnt(12)
    v_mfma_f32_32x32x16_bf16 v[176:191], v[204:207], v[12:15], v[176:191]
    ds_read_b64_tr_b16 v[200:201], v226 offset:20480
    ds_read_b64_tr_b16 v[202:203], v226 offset:20992
    s_waitcnt lgkmcnt(12)
    v_mfma_f32_32x32x16_bf16 v[176:191], v[208:211], v[16:19], v[176:191]
    ds_read_b64_tr_b16 v[204:205], v226 offset:22528
    ds_read_b64_tr_b16 v[206:207], v226 offset:23040
    s_waitcnt lgkmcnt(12)
    v_mfma_f32_32x32x16_bf16 v[176:191], v[212:215], v[20:23], v[176:191]
    ds_read_b64_tr_b16 v[208:209], v226 offset:24576
    ds_read_b64_tr_b16 v[210:211], v226 offset:25088
    s_waitcnt lgkmcnt(12)
    v_mfma_f32_32x32x16_bf16 v[176:191], v[216:219], v[24:27], v[176:191]
    ds_read_b64_tr_b16 v[212:213], v226 offset:26624
    ds_read_b64_tr_b16 v[214:215], v226 offset:27136
    s_waitcnt lgkmcnt(12)
    v_mfma_f32_32x32x16_bf16 v[176:191], v[220:223], v[28:31], v[176:191]
    v_lshrrev_b32 v242, 9, v228
    v_lshlrev_b32 v242, 9, v242
    v_subrev_u32 v242, s50, v242
    v_sub_u32 v243, v227, v242
    v_sub_u32 v242, v226, v242
    ds_read_b64_tr_b16 v[244:245], v242 offset:0
    ds_read_b64_tr_b16 v[246:247], v242 offset:1024
    ds_read_b64_tr_b16 v[248:249], v243 offset:0
    ds_read_b64_tr_b16 v[250:251], v243 offset:1024
    s_waitcnt lgkmcnt(0)
    s_lshl_b32 s51, s3, 19
    s_lshl_b32 s46, s2, 10
    s_add_u32 s51, s51, s46
    s_add_u32 s51, s51, 0x4000000
    s_add_u32 s46, s51, 0x0
    buffer_store_dwordx4 v[244:247], v228, s[28:31], s46 offen sc1
    s_add_u32 s46, s51, 0x40000
    buffer_store_dwordx4 v[248:251], v228, s[28:31], s46 offen sc1
    s_waitcnt vmcnt(6)
    s_barrier
    s_add_u32 s46, s45, 0x0
    buffer_store_dwordx4 v[128:131], v228, s[28:31], s46 offen offset:0 sc1
    ds_read_b64_tr_b16 v[216:217], v226 offset:28672
    ds_read_b64_tr_b16 v[218:219], v226 offset:29184
    v_mfma_f32_32x32x16_bf16 v[160:175], v[192:195], v[32:35], v[160:175]
    ds_read_b64_tr_b16 v[220:221], v226 offset:30720
    ds_read_b64_tr_b16 v[222:223], v226 offset:31232
    v_mfma_f32_32x32x16_bf16 v[160:175], v[196:199], v[36:39], v[160:175]
    ds_read_b64_tr_b16 v[192:193], v227 offset:16384
    ds_read_b64_tr_b16 v[194:195], v227 offset:16896
    v_mfma_f32_32x32x16_bf16 v[160:175], v[200:203], v[40:43], v[160:175]
    ds_read_b64_tr_b16 v[196:197], v227 offset:18432
    ds_read_b64_tr_b16 v[198:199], v227 offset:18944
    v_mfma_f32_32x32x16_bf16 v[160:175], v[204:207], v[44:47], v[160:175]
    ds_read_b64_tr_b16 v[200:201], v227 offset:20480
    ds_read_b64_tr_b16 v[202:203], v227 offset:20992
    v_mfma_f32_32x32x16_bf16 v[160:175], v[208:211], v[48:51], v[160:175]
    ds_read_b64_tr_b16 v[204:205], v227 offset:22528
    ds_read_b64_tr_b16 v[206:207], v227 offset:23040
    v_mfma_f32_32x32x16_bf16 v[160:175], v[212:215], v[52:55], v[160:175]
    ds_read_b64_tr_b16 v[208:209], v227 offset:24576
    ds_read_b64_tr_b16 v[210:211], v227 offset:25088
    s_waitcnt lgkmcnt(12)
    v_mfma_f32_32x32x16_bf16 v[160:175], v[216:219], v[56:59], v[160:175]
    ds_read_b64_tr_b16 v[212:213], v227 offset:26624
    ds_read_b64_tr_b16 v[214:215], v227 offset:27136
    s_waitcnt lgkmcnt(12)
    v_mfma_f32_32x32x16_bf16 v[160:175], v[220:223], v[60:63], v[160:175]
    ds_read_b64_tr_b16 v[216:217], v227 offset:28672
    ds_read_b64_tr_b16 v[218:219], v227 offset:29184
    s_waitcnt lgkmcnt(12)
    v_mfma_f32_32x32x16_bf16 v[176:191], v[192:195], v[32:35], v[176:191]
    ds_read_b64_tr_b16 v[220:221], v227 offset:30720
    ds_read_b64_tr_b16 v[222:223], v227 offset:31232
    s_waitcnt lgkmcnt(12)
    v_mfma_f32_32x32x16_bf16 v[176:191], v[196:199], v[36:39], v[176:191]
    ds_read_b64_tr_b16 v[192:193], v226 offset:32768
    ds_read_b64_tr_b16 v[194:195], v226 offset:33280
    s_waitcnt lgkmcnt(12)
    v_mfma_f32_32x32x16_bf16 v[176:191], v[200:203], v[40:43], v[176:191]
    ds_read_b64_tr_b16 v[196:197], v226 offset:34816
    ds_read_b64_tr_b16 v[198:199], v226 offset:35328
    s_waitcnt lgkmcnt(12)
    v_mfma_f32_32x32x16_bf16 v[176:191], v[204:207], v[44:47], v[176:191]
    ds_read_b64_tr_b16 v[200:201], v226 offset:36864
    ds_read_b64_tr_b16 v[202:203], v226 offset:37376
    s_waitcnt lgkmcnt(12)
    v_mfma_f32_32x32x16_bf16 v[176:191], v[208:211], v[48:51], v[176:191]
    ds_read_b64_tr_b16 v[204:205], v226 offset:38912
    ds_read_b64_tr_b16 v[206:207], v226 offset:39424
    s_waitcnt lgkmcnt(12)
    v_mfma_f32_32x32x16_bf16 v[176:191], v[212:215], v[52:55], v[176:191]
    ds_read_b64_tr_b16 v[208:209], v226 offset:40960
    ds_read_b64_tr_b16 v[210:211], v226 offset:41472
    s_waitcnt lgkmcnt(12)
    v_mfma_f32_32x32x16_bf16 v[176:191], v[216:219], v[56:59], v[176:191]
    ds_read_b64_tr_b16 v[212:213], v226 offset:43008
    ds_read_b64_tr_b16 v[214:215], v226 offset:43520
    s_waitcnt lgkmcnt(12)
    v_mfma_f32_32x32x16_bf16 v[176:191], v[220:223], v[60:63], v[176:191]
    v_bfe_u32 v241, v228, 5, 3
    v_mul_u32_u24 v241, 12288, v241
    v_bfe_u32 v243, v228, 4, 1
    v_lshl_add_u32 v241, v243, 9, v241
    v_lshrrev_b32 v243, 8, v228
    v_lshl_add_u32 v241, v243, 2, v241
    s_lshl_b32 s46, s3, 4
    s_add_u32 s46, s46, 69632
    v_add_u32 v241, s46, v241
    ds_read_b32 v244, v241 offset:0
    ds_read_b32 v245, v241 offset:128
    ds_read_b32 v246, v241 offset:256
    ds_read_b32 v247, v241 offset:384
    v_lshlrev_b32 v243, 13, v243
    v_and_b32 v241, 0xf0, v228
    v_add_u32 v241, v241, v243
    s_and_b32 s51, s2, 7
    s_lshl_b32 s51, s51, 18
    s_lshl_b32 s46, s3, 15
    s_add_u32 s51, s51, s46
    s_lshr_b32 s46, s2, 3
    s_lshl_b32 s46, s46, 8
    s_add_u32 s51, s51, s46
    s_add_u32 s51, s51, 0x4400000
    s_waitcnt lgkmcnt(0)
    buffer_store_dwordx4 v[244:247], v241, s[28:31], s51 offen sc1
    s_waitcnt vmcnt(4)
    s_barrier
    s_add_u32 s46, s45, 0x0
    buffer_store_dwordx4 v[136:139], v228, s[28:31], s46 offen offset:1024 sc1
    ds_read_b64_tr_b16 v[216:217], v226 offset:45056
    ds_read_b64_tr_b16 v[218:219], v226 offset:45568
    v_mfma_f32_32x32x16_bf16 v[160:175], v[192:195], v[64:67], v[160:175]
    ds_read_b64_tr_b16 v[220:221], v226 offset:47104
    ds_read_b64_tr_b16 v[222:223], v226 offset:47616
    v_mfma_f32_32x32x16_bf16 v[160:175], v[196:199], v[68:71], v[160:175]
    ds_read_b64_tr_b16 v[192:193], v227 offset:32768
    ds_read_b64_tr_b16 v[194:195], v227 offset:33280
    v_mfma_f32_32x32x16_bf16 v[160:175], v[200:203], v[72:75], v[160:175]
    ds_read_b64_tr_b16 v[196:197], v227 offset:34816
    ds_read_b64_tr_b16 v[198:199], v227 offset:35328
    v_mfma_f32_32x32x16_bf16 v[160:175], v[204:207], v[76:79], v[160:175]
    ds_read_b64_tr_b16 v[200:201], v227 offset:36864
    ds_read_b64_tr_b16 v[202:203], v227 offset:37376
    v_mfma_f32_32x32x16_bf16 v[160:175], v[208:211], v[80:83], v[160:175]
    ds_read_b64_tr_b16 v[204:205], v227 offset:38912
    ds_read_b64_tr_b16 v[206:207], v227 offset:39424
    v_mfma_f32_32x32x16_bf16 v[160:175], v[212:215], v[84:87], v[160:175]
    ds_read_b64_tr_b16 v[208:209], v227 offset:40960
    ds_read_b64_tr_b16 v[210:211], v227 offset:41472
    s_waitcnt lgkmcnt(12)
    v_mfma_f32_32x32x16_bf16 v[160:175], v[216:219], v[88:91], v[160:175]
    ds_read_b64_tr_b16 v[212:213], v227 offset:43008
    ds_read_b64_tr_b16 v[214:215], v227 offset:43520
    s_waitcnt lgkmcnt(12)
    v_mfma_f32_32x32x16_bf16 v[160:175], v[220:223], v[92:95], v[160:175]
    ds_read_b64_tr_b16 v[216:217], v227 offset:45056
    ds_read_b64_tr_b16 v[218:219], v227 offset:45568
    s_waitcnt lgkmcnt(12)
    v_mfma_f32_32x32x16_bf16 v[176:191], v[192:195], v[64:67], v[176:191]
    ds_read_b64_tr_b16 v[220:221], v227 offset:47104
    ds_read_b64_tr_b16 v[222:223], v227 offset:47616
    s_waitcnt lgkmcnt(12)
    v_mfma_f32_32x32x16_bf16 v[176:191], v[196:199], v[68:71], v[176:191]
    ds_read_b64_tr_b16 v[192:193], v226 offset:49152
    ds_read_b64_tr_b16 v[194:195], v226 offset:49664
    s_waitcnt lgkmcnt(12)
    v_mfma_f32_32x32x16_bf16 v[176:191], v[200:203], v[72:75], v[176:191]
    ds_read_b64_tr_b16 v[196:197], v226 offset:51200
    ds_read_b64_tr_b16 v[198:199], v226 offset:51712
    s_waitcnt lgkmcnt(12)
    v_mfma_f32_32x32x16_bf16 v[176:191], v[204:207], v[76:79], v[176:191]
    ds_read_b64_tr_b16 v[200:201], v226 offset:53248
    ds_read_b64_tr_b16 v[202:203], v226 offset:53760
    s_waitcnt lgkmcnt(12)
    v_mfma_f32_32x32x16_bf16 v[176:191], v[208:211], v[80:83], v[176:191]
    ds_read_b64_tr_b16 v[204:205], v226 offset:55296
    ds_read_b64_tr_b16 v[206:207], v226 offset:55808
    s_waitcnt lgkmcnt(12)
    v_mfma_f32_32x32x16_bf16 v[176:191], v[212:215], v[84:87], v[176:191]
    ds_read_b64_tr_b16 v[208:209], v226 offset:57344
    ds_read_b64_tr_b16 v[210:211], v226 offset:57856
    s_waitcnt lgkmcnt(12)
    v_mfma_f32_32x32x16_bf16 v[176:191], v[216:219], v[88:91], v[176:191]
    ds_read_b64_tr_b16 v[212:213], v226 offset:59392
    ds_read_b64_tr_b16 v[214:215], v226 offset:59904
    s_waitcnt lgkmcnt(12)
    v_mfma_f32_32x32x16_bf16 v[176:191], v[220:223], v[92:95], v[176:191]
    s_barrier
    s_add_u32 s46, s45, 0x0
    buffer_store_dwordx4 v[144:147], v228, s[28:31], s46 offen offset:2048 sc1
    s_add_u32 s46, s45, 0x0
    buffer_store_dwordx4 v[152:155], v228, s[28:31], s46 offen offset:3072 sc1
    ds_read_b64_tr_b16 v[216:217], v226 offset:61440
    ds_read_b64_tr_b16 v[218:219], v226 offset:61952
    s_waitcnt lgkmcnt(12)
    v_mfma_f32_32x32x16_bf16 v[160:175], v[192:195], v[96:99], v[160:175]
    ds_read_b64_tr_b16 v[220:221], v226 offset:63488
    ds_read_b64_tr_b16 v[222:223], v226 offset:64000
    s_waitcnt lgkmcnt(12)
    v_mfma_f32_32x32x16_bf16 v[160:175], v[196:199], v[100:103], v[160:175]
    ds_read_b64_tr_b16 v[192:193], v227 offset:49152
    ds_read_b64_tr_b16 v[194:195], v227 offset:49664
    s_waitcnt lgkmcnt(12)
    v_mfma_f32_32x32x16_bf16 v[160:175], v[200:203], v[104:107], v[160:175]
    ds_read_b64_tr_b16 v[196:197], v227 offset:51200
    ds_read_b64_tr_b16 v[198:199], v227 offset:51712
    s_waitcnt lgkmcnt(12)
    v_mfma_f32_32x32x16_bf16 v[160:175], v[204:207], v[108:111], v[160:175]
    ds_read_b64_tr_b16 v[200:201], v227 offset:53248
    ds_read_b64_tr_b16 v[202:203], v227 offset:53760
    s_waitcnt lgkmcnt(12)
    v_mfma_f32_32x32x16_bf16 v[160:175], v[208:211], v[112:115], v[160:175]
    ds_read_b64_tr_b16 v[204:205], v227 offset:55296
    ds_read_b64_tr_b16 v[206:207], v227 offset:55808
    s_waitcnt lgkmcnt(12)
    v_mfma_f32_32x32x16_bf16 v[160:175], v[212:215], v[116:119], v[160:175]
    ds_read_b64_tr_b16 v[208:209], v227 offset:57344
    ds_read_b64_tr_b16 v[210:211], v227 offset:57856
    s_waitcnt lgkmcnt(12)
    v_mfma_f32_32x32x16_bf16 v[160:175], v[216:219], v[120:123], v[160:175]
    ds_read_b64_tr_b16 v[212:213], v227 offset:59392
    ds_read_b64_tr_b16 v[214:215], v227 offset:59904
    s_waitcnt lgkmcnt(12)
    v_mfma_f32_32x32x16_bf16 v[160:175], v[220:223], v[124:127], v[160:175]
    ds_read_b64_tr_b16 v[216:217], v227 offset:61440
    ds_read_b64_tr_b16 v[218:219], v227 offset:61952
    s_waitcnt lgkmcnt(12)
    v_mfma_f32_32x32x16_bf16 v[176:191], v[192:195], v[96:99], v[176:191]
    ds_read_b64_tr_b16 v[220:221], v227 offset:63488
    ds_read_b64_tr_b16 v[222:223], v227 offset:64000
    s_waitcnt lgkmcnt(12)
    v_mfma_f32_32x32x16_bf16 v[176:191], v[196:199], v[100:103], v[176:191]
    s_waitcnt lgkmcnt(10)
    v_mfma_f32_32x32x16_bf16 v[176:191], v[200:203], v[104:107], v[176:191]
    s_waitcnt lgkmcnt(8)
    v_mfma_f32_32x32x16_bf16 v[176:191], v[204:207], v[108:111], v[176:191]
    v_mul_f32 v160, s49, v160
    v_mul_f32 v161, s49, v161
    v_mul_f32 v162, s49, v162
    v_mul_f32 v163, s49, v163
    v_mul_f32 v164, s49, v164
    v_mul_f32 v165, s49, v165
    v_mul_f32 v166, s49, v166
    v_mul_f32 v167, s49, v167
    v_mul_f32 v168, s49, v168
    v_mul_f32 v169, s49, v169
    v_mul_f32 v170, s49, v170
    v_mul_f32 v171, s49, v171
    v_mul_f32 v172, s49, v172
    v_mul_f32 v173, s49, v173
    v_mul_f32 v174, s49, v174
    v_mul_f32 v175, s49, v175
    v_cvt_pk_bf16_f32 v160, v160, v161
    v_cvt_pk_bf16_f32 v161, v162, v163
    v_cvt_pk_bf16_f32 v162, v164, v165
    v_cvt_pk_bf16_f32 v163, v166, v167
    v_cvt_pk_bf16_f32 v168, v168, v169
    v_cvt_pk_bf16_f32 v169, v170, v171
    v_cvt_pk_bf16_f32 v170, v172, v173
    v_cvt_pk_bf16_f32 v171, v174, v175
    s_waitcnt lgkmcnt(6)
    v_mfma_f32_32x32x16_bf16 v[176:191], v[208:211], v[112:115], v[176:191]
    s_waitcnt lgkmcnt(4)
    v_mfma_f32_32x32x16_bf16 v[176:191], v[212:215], v[116:119], v[176:191]
    s_waitcnt lgkmcnt(2)
    v_mfma_f32_32x32x16_bf16 v[176:191], v[216:219], v[120:123], v[176:191]
    s_waitcnt lgkmcnt(0)
    v_mfma_f32_32x32x16_bf16 v[176:191], v[220:223], v[124:127], v[176:191]
    s_nop 11
    v_mul_f32 v176, s49, v176
    v_mul_f32 v177, s49, v177
    v_mul_f32 v178, s49, v178
    v_mul_f32 v179, s49, v179
    v_mul_f32 v180, s49, v180
    v_mul_f32 v181, s49, v181
    v_mul_f32 v182, s49, v182
    v_mul_f32 v183, s49, v183
    v_mul_f32 v184, s49, v184
    v_mul_f32 v185, s49, v185
    v_mul_f32 v186, s49, v186
    v_mul_f32 v187, s49, v187
    v_mul_f32 v188, s49, v188
    v_mul_f32 v189, s49, v189
    v_mul_f32 v190, s49, v190
    v_mul_f32 v191, s49, v191
    v_cvt_pk_bf16_f32 v176, v176, v177
    v_cvt_pk_bf16_f32 v177, v178, v179
    v_cvt_pk_bf16_f32 v178, v180, v181
    v_cvt_pk_bf16_f32 v179, v182, v183
    v_cvt_pk_bf16_f32 v184, v184, v185
    v_cvt_pk_bf16_f32 v185, v186, v187
    v_cvt_pk_bf16_f32 v186, v188, v189
    v_cvt_pk_bf16_f32 v187, v190, v191
    s_add_u32 s46, s45, 0x1000
    buffer_store_dwordx4 v[160:163], v228, s[28:31], s46 offen offset:0 sc1
    s_add_u32 s46, s45, 0x1000
    buffer_store_dwordx4 v[168:171], v228, s[28:31], s46 offen offset:1024 sc1
    s_add_u32 s46, s45, 0x1000
    buffer_store_dwordx4 v[176:179], v228, s[28:31], s46 offen offset:2048 sc1
    s_add_u32 s46, s45, 0x1000
    buffer_store_dwordx4 v[184:187], v228, s[28:31], s46 offen offset:3072 sc1
    s_nop 1
L_k1_end:
    s_endpgm
.globl k2_attn_kernel
.p2align 8
.type k2_attn_kernel,@function
k2_attn_kernel:
    s_cmp_ge_u32 s2, 256
    s_cbranch_scc1 L_k2_end
    s_load_dwordx2 s[42:43], s[0:1], 136
    v_lshrrev_b32 v243, 6, v0
    s_nop 0
    v_readfirstlane_b32 s3, v243
    v_and_b32 v243, 63, v0
    v_lshlrev_b32 v234, 4, v243
    s_and_b32 s4, s2, 7
    s_lshl_b32 s4, s4, 2
    s_lshr_b32 s5, s2, 3
    s_and_b32 s5, s5, 3
    s_add_u32 s4, s4, s5
    s_lshr_b32 s5, s2, 5
    s_lshr_b32 s6, s3, 2
    s_and_b32 s7, s3, 3
    s_sub_u32 s12, 16, s5
    s_cmp_eq_u32 s3, 4
    s_cselect_b32 s40, 1, 0
    s_cmp_eq_u32 s3, 5
    s_cselect_b32 s40, 1, s40
    v_and_b32 v242, 31, v243
    v_lshrrev_b32 v244, 5, v243
    v_lshlrev_b32 v244, 2, v244
    v_sub_u32 v242, v242, v244
    s_lshl_b32 s23, s7, 5
    s_lshl_b32 s24, s6, 6
    s_sub_u32 s23, s23, s24
    v_add_u32 v242, s23, v242
    v_mov_b32 v245, 0xff800000
    s_lshl_b32 s23, s6, 16
    v_add_u32 v232, s23, v234
    v_add_u32 v233, 0x8000, v232
    v_xor_b32 v233, 0x4000, v233
    s_lshl_b32 s24, s7, 12
    s_add_u32 s20, s23, s24
    s_add_u32 s21, s20, 0x8000
    s_lshl_b32 s24, s7, 13
    s_add_u32 s24, s24, 0x20000
    v_add_u32 v246, s24, v234
    s_lshl_b32 s18, s4, 19
    s_lshl_b32 s23, s6, 14
    s_add_u32 s18, s18, s23
    s_lshl_b32 s23, s7, 12
    s_add_u32 s18, s18, s23
    s_add_u32 s19, s18, 0x2000000
    s_add_u32 s18, s18, 0x1000000
    s_mov_b32 s26, 0x58800000
    s_mov_b32 s27, 0x00000000
    s_mov_b32 s38, 0x80000000
    s_mov_b32 s39, 0x3f800000
    s_waitcnt lgkmcnt(0)
    s_mov_b32 s8, s42
    s_and_b32 s9, s43, 0xffff
    s_mov_b32 s10, 0x4000000
    s_mov_b32 s11, 0x20000
    s_mov_b32 s14, 0
    s_sub_u32 s17, 15, s5
    s_mov_b32 s25, 0
    s_add_u32 s23, s14, 0
    s_and_b32 s36, s23, 1
    s_lshl_b32 s36, s36, 14
    s_add_u32 m0, s36, s20
    s_min_u32 s23, s23, 16
    s_cmp_ge_u32 s23, s12
    s_cselect_b32 s24, s12, 0
    s_sub_u32 s23, s23, s24
    s_lshl_b32 s23, s23, 15
    s_add_u32 s23, s23, s18
    buffer_load_dwordx4 v234, s[8:11], s23 offen offset:0 lds
    buffer_load_dwordx4 v234, s[8:11], s23 offen offset:1024 lds
    buffer_load_dwordx4 v234, s[8:11], s23 offen offset:2048 lds
    buffer_load_dwordx4 v234, s[8:11], s23 offen offset:3072 lds
    s_lshl_b32 s23, s4, 6
    s_lshl_b32 s24, s17, 2
    s_add_u32 s23, s23, s24
    s_add_u32 s23, s23, s7
    s_lshl_b32 s23, s23, 13
    s_add_u32 s24, s23, 4096
    buffer_load_dwordx4 v[0:3], v234, s[8:11], s23 offen offset:0
    buffer_load_dwordx4 v[4:7], v234, s[8:11], s23 offen offset:1024
    buffer_load_dwordx4 v[8:11], v234, s[8:11], s23 offen offset:2048
    buffer_load_dwordx4 v[12:15], v234, s[8:11], s23 offen offset:3072
    buffer_load_dwordx4 v[16:19], v234, s[8:11], s24 offen offset:0
    buffer_load_dwordx4 v[20:23], v234, s[8:11], s24 offen offset:1024
    buffer_load_dwordx4 v[24:27], v234, s[8:11], s24 offen offset:2048
    buffer_load_dwordx4 v[28:31], v234, s[8:11], s24 offen offset:3072
    s_add_u32 s23, s14, 1
    s_and_b32 s36, s23, 1
    s_lshl_b32 s36, s36, 14
    s_add_u32 m0, s36, s20
    s_min_u32 s23, s23, 16
    s_cmp_ge_u32 s23, s12
    s_cselect_b32 s24, s12, 0
    s_sub_u32 s23, s23, s24
    s_lshl_b32 s23, s23, 15
    s_add_u32 s23, s23, s18
    buffer_load_dwordx4 v234, s[8:11], s23 offen offset:0 lds
    buffer_load_dwordx4 v234, s[8:11], s23 offen offset:1024 lds
    buffer_load_dwordx4 v234, s[8:11], s23 offen offset:2048 lds
    buffer_load_dwordx4 v234, s[8:11], s23 offen offset:3072 lds
    s_add_u32 s23, s14, 0
    s_and_b32 s36, s23, 1
    s_lshl_b32 s36, s36, 14
    s_add_u32 m0, s36, s21
    s_min_u32 s23, s23, 16
    s_cmp_ge_u32 s23, s12
    s_cselect_b32 s24, s12, 0
    s_sub_u32 s23, s23, s24
    s_lshl_b32 s23, s23, 15
    s_add_u32 s23, s23, s19
    buffer_load_dwordx4 v234, s[8:11], s23 offen offset:0 lds
    buffer_load_dwordx4 v234, s[8:11], s23 offen offset:1024 lds
    buffer_load_dwordx4 v234, s[8:11], s23 offen offset:2048 lds
    buffer_load_dwordx4 v234, s[8:11], s23 offen offset:3072 lds
    s_waitcnt vmcnt(8)
L_k2_qblock:
    s_add_u32 s16, s17, 1
    s_mov_b32 s15, 0
    v_mov_b32 v32, 0
    v_mov_b32 v33, 0
    v_mov_b32 v34, 0
    v_mov_b32 v35, 0
    v_mov_b32 v36, 0
    v_mov_b32 v37, 0
    v_mov_b32 v38, 0
    v_mov_b32 v39, 0
    v_mov_b32 v40, 0
    v_mov_b32 v41, 0
    v_mov_b32 v42, 0
    v_mov_b32 v43, 0
    v_mov_b32 v44, 0
    v_mov_b32 v45, 0
    v_mov_b32 v46, 0
    v_mov_b32 v47, 0
    v_mov_b32 v48, 0
    v_mov_b32 v49, 0
    v_mov_b32 v50, 0
    v_mov_b32 v51, 0
    v_mov_b32 v52, 0
    v_mov_b32 v53, 0
    v_mov_b32 v54, 0
    v_mov_b32 v55, 0
    v_mov_b32 v56, 0
    v_mov_b32 v57, 0
    v_mov_b32 v58, 0
    v_mov_b32 v59, 0
    v_mov_b32 v60, 0
    v_mov_b32 v61, 0
    v_mov_b32 v62, 0
    v_mov_b32 v63, 0
    v_mov_b32 v64, 0
    v_mov_b32 v65, 0
    v_mov_b32 v66, 0
    v_mov_b32 v67, 0
    v_mov_b32 v68, 0
    v_mov_b32 v69, 0
    v_mov_b32 v70, 0
    v_mov_b32 v71, 0
    v_mov_b32 v72, 0
    v_mov_b32 v73, 0
    v_mov_b32 v74, 0
    v_mov_b32 v75, 0
    v_mov_b32 v76, 0
    v_mov_b32 v77, 0
    v_mov_b32 v78, 0
    v_mov_b32 v79, 0
    v_mov_b32 v80, 0
    v_mov_b32 v81, 0
    v_mov_b32 v82, 0
    v_mov_b32 v83, 0
    v_mov_b32 v84, 0
    v_mov_b32 v85, 0
    v_mov_b32 v86, 0
    v_mov_b32 v87, 0
    v_mov_b32 v88, 0
    v_mov_b32 v89, 0
    v_mov_b32 v90, 0
    v_mov_b32 v91, 0
    v_mov_b32 v92, 0
    v_mov_b32 v93, 0
    v_mov_b32 v94, 0
    v_mov_b32 v95, 0
    v_mov_b32 v144, s38
    v_mov_b32 v145, s38
    v_mov_b32 v146, s38
    v_mov_b32 v147, s38
    v_mov_b32 v148, s38
    v_mov_b32 v149, s38
    v_mov_b32 v150, s38
    v_mov_b32 v151, s38
    v_mov_b32 v152, s38
    v_mov_b32 v153, s38
    v_mov_b32 v154, s38
    v_mov_b32 v155, s38
    v_mov_b32 v156, s38
    v_mov_b32 v157, s38
    v_mov_b32 v158, s38
    v_mov_b32 v159, s38
    v_mov_b32 v235, 0
    v_mov_b32 v236, 0
    s_barrier
    ds_read_b128 v[192:195], v232 offset:0
    ds_read_b128 v[196:199], v232 offset:1024
    ds_read_b128 v[200:203], v232 offset:2048
    ds_read_b128 v[204:207], v232 offset:3072
    ds_read_b128 v[208:211], v232 offset:4096
    ds_read_b128 v[212:215], v232 offset:5120
    s_cmp_eq_u32 s6, 0
    s_cbranch_scc1 L_k2_m0
    s_barrier
L_k2_m0:
    s_add_u32 s41, s15, s40
    s_cmp_eq_u32 s41, s16
    s_cbranch_scc1 L_k2_mskip
    ds_read_b128 v[216:219], v232 offset:6144
    s_waitcnt lgkmcnt(6)
    v_mfma_f32_32x32x16_bf16 v[96:111], v[192:195], v[0:3], v[144:159]
    ds_read_b128 v[220:223], v232 offset:7168
    s_waitcnt lgkmcnt(6)
    v_mfma_f32_32x32x16_bf16 v[96:111], v[196:199], v[4:7], v[96:111]
    ds_read_b128 v[192:195], v232 offset:8192
    s_waitcnt lgkmcnt(6)
    v_mfma_f32_32x32x16_bf16 v[96:111], v[200:203], v[8:11], v[96:111]
    ds_read_b128 v[196:199], v232 offset:9216
    s_waitcnt lgkmcnt(6)
    v_mfma_f32_32x32x16_bf16 v[96:111], v[204:207], v[12:15], v[96:111]
    ds_read_b128 v[200:203], v232 offset:10240
    s_waitcnt lgkmcnt(6)
    v_mfma_f32_32x32x16_bf16 v[96:111], v[208:211], v[16:19], v[96:111]
    ds_read_b128 v[204:207], v232 offset:11264
    s_waitcnt lgkmcnt(6)
    v_mfma_f32_32x32x16_bf16 v[96:111], v[212:215], v[20:23], v[96:111]
    ds_read_b128 v[208:211], v232 offset:12288
    s_waitcnt lgkmcnt(6)
    v_mfma_f32_32x32x16_bf16 v[96:111], v[216:219], v[24:27], v[96:111]
    ds_read_b128 v[212:215], v232 offset:13312
    s_waitcnt lgkmcnt(6)
    v_mfma_f32_32x32x16_bf16 v[96:111], v[220:223], v[28:31], v[96:111]
    ds_read_b128 v[216:219], v232 offset:14336
    s_waitcnt lgkmcnt(6)
    v_mfma_f32_32x32x16_bf16 v[112:127], v[192:195], v[0:3], v[144:159]
    ds_read_b128 v[220:223], v232 offset:15360
    s_waitcnt lgkmcnt(6)
    v_mfma_f32_32x32x16_bf16 v[112:127], v[196:199], v[4:7], v[112:127]
    s_waitcnt lgkmcnt(5)
    v_mfma_f32_32x32x16_bf16 v[112:127], v[200:203], v[8:11], v[112:127]
    s_waitcnt lgkmcnt(4)
    v_mfma_f32_32x32x16_bf16 v[112:127], v[204:207], v[12:15], v[112:127]
    s_waitcnt lgkmcnt(3)
    v_mfma_f32_32x32x16_bf16 v[112:127], v[208:211], v[16:19], v[112:127]
    s_waitcnt lgkmcnt(2)
    v_mfma_f32_32x32x16_bf16 v[112:127], v[212:215], v[20:23], v[112:127]
    s_waitcnt lgkmcnt(1)
    v_mfma_f32_32x32x16_bf16 v[112:127], v[216:219], v[24:27], v[112:127]
    s_waitcnt lgkmcnt(0)
    v_mfma_f32_32x32x16_bf16 v[112:127], v[220:223], v[28:31], v[112:127]
    s_nop 10
    s_branch L_k2_mdone
L_k2_mskip:
    s_waitcnt lgkmcnt(0)
    s_branch L_k2_mdone
L_k2_pvonly:
    s_waitcnt lgkmcnt(0)
    ds_read_b128 v[192:195], v233 offset:0
    ds_read_b128 v[196:199], v233 offset:1024
    ds_read_b128 v[200:203], v233 offset:2048
    ds_read_b128 v[204:207], v233 offset:3072
    ds_read_b128 v[208:211], v233 offset:4096
    ds_read_b128 v[212:215], v233 offset:5120
    ds_read_b128 v[216:219], v233 offset:6144
    s_waitcnt lgkmcnt(6)
    v_mfma_f32_32x32x16_bf16 v[32:47], v[192:195], v[128:131], v[32:47]
    ds_read_b128 v[220:223], v233 offset:7168
    s_waitcnt lgkmcnt(6)
    v_mfma_f32_32x32x16_bf16 v[32:47], v[196:199], v[132:135], v[32:47]
    ds_read_b128 v[192:195], v233 offset:8192
    s_waitcnt lgkmcnt(6)
    v_mfma_f32_32x32x16_bf16 v[32:47], v[200:203], v[136:139], v[32:47]
    ds_read_b128 v[196:199], v233 offset:9216
    s_waitcnt lgkmcnt(6)
    v_mfma_f32_32x32x16_bf16 v[32:47], v[204:207], v[140:143], v[32:47]
    ds_read_b128 v[200:203], v233 offset:10240
    s_waitcnt lgkmcnt(6)
    v_mfma_f32_32x32x16_bf16 v[48:63], v[208:211], v[128:131], v[48:63]
    ds_read_b128 v[204:207], v233 offset:11264
    s_waitcnt lgkmcnt(6)
    v_mfma_f32_32x32x16_bf16 v[48:63], v[212:215], v[132:135], v[48:63]
    ds_read_b128 v[208:211], v233 offset:12288
    s_waitcnt lgkmcnt(6)
    v_mfma_f32_32x32x16_bf16 v[48:63], v[216:219], v[136:139], v[48:63]
    ds_read_b128 v[212:215], v233 offset:13312
    s_waitcnt lgkmcnt(6)
    v_mfma_f32_32x32x16_bf16 v[48:63], v[220:223], v[140:143], v[48:63]
    ds_read_b128 v[216:219], v233 offset:14336
    s_waitcnt lgkmcnt(6)
    v_mfma_f32_32x32x16_bf16 v[64:79], v[192:195], v[128:131], v[64:79]
    ds_read_b128 v[220:223], v233 offset:15360
    s_waitcnt lgkmcnt(6)
    v_mfma_f32_32x32x16_bf16 v[64:79], v[196:199], v[132:135], v[64:79]
    s_waitcnt lgkmcnt(5)
    v_mfma_f32_32x32x16_bf16 v[64:79], v[200:203], v[136:139], v[64:79]
    s_waitcnt lgkmcnt(4)
    v_mfma_f32_32x32x16_bf16 v[64:79], v[204:207], v[140:143], v[64:79]
    s_waitcnt lgkmcnt(3)
    v_mfma_f32_32x32x16_bf16 v[80:95], v[208:211], v[128:131], v[80:95]
    s_waitcnt lgkmcnt(2)
    v_mfma_f32_32x32x16_bf16 v[80:95], v[212:215], v[132:135], v[80:95]
    s_waitcnt lgkmcnt(1)
    v_mfma_f32_32x32x16_bf16 v[80:95], v[216:219], v[136:139], v[80:95]
    s_waitcnt lgkmcnt(0)
    v_mfma_f32_32x32x16_bf16 v[80:95], v[220:223], v[140:143], v[80:95]
    s_nop 10
    s_branch L_k2_mdone
L_k2_loop:
    s_barrier
    s_add_u32 s41, s15, s40
    s_cmp_eq_u32 s41, s16
    s_cbranch_scc1 L_k2_pvonly
    ds_read_b128 v[216:219], v232 offset:6144
    s_waitcnt lgkmcnt(6)
    v_mfma_f32_32x32x16_bf16 v[96:111], v[192:195], v[0:3], v[144:159]
    ds_read_b128 v[220:223], v232 offset:7168
    s_waitcnt lgkmcnt(6)
    v_mfma_f32_32x32x16_bf16 v[96:111], v[196:199], v[4:7], v[96:111]
    ds_read_b128 v[192:195], v232 offset:8192
    s_waitcnt lgkmcnt(6)
    v_mfma_f32_32x32x16_bf16 v[96:111], v[200:203], v[8:11], v[96:111]
    ds_read_b128 v[196:199], v232 offset:9216
    s_waitcnt lgkmcnt(6)
    v_mfma_f32_32x32x16_bf16 v[96:111], v[204:207], v[12:15], v[96:111]
    ds_read_b128 v[200:203], v232 offset:10240
    s_waitcnt lgkmcnt(6)
    v_mfma_f32_32x32x16_bf16 v[96:111], v[208:211], v[16:19], v[96:111]
    ds_read_b128 v[204:207], v232 offset:11264
    s_waitcnt lgkmcnt(6)
    v_mfma_f32_32x32x16_bf16 v[96:111], v[212:215], v[20:23], v[96:111]
    ds_read_b128 v[208:211], v232 offset:12288
    s_waitcnt lgkmcnt(6)
    v_mfma_f32_32x32x16_bf16 v[96:111], v[216:219], v[24:27], v[96:111]
    ds_read_b128 v[212:215], v232 offset:13312
    s_waitcnt lgkmcnt(6)
    v_mfma_f32_32x32x16_bf16 v[96:111], v[220:223], v[28:31], v[96:111]
    ds_read_b128 v[216:219], v232 offset:14336
    s_waitcnt lgkmcnt(6)
    v_mfma_f32_32x32x16_bf16 v[112:127], v[192:195], v[0:3], v[144:159]
    ds_read_b128 v[220:223], v232 offset:15360
    s_waitcnt lgkmcnt(6)
    v_mfma_f32_32x32x16_bf16 v[112:127], v[196:199], v[4:7], v[112:127]
    ds_read_b128 v[192:195], v233 offset:0
    s_waitcnt lgkmcnt(6)
    v_mfma_f32_32x32x16_bf16 v[112:127], v[200:203], v[8:11], v[112:127]
    ds_read_b128 v[196:199], v233 offset:1024
    s_waitcnt lgkmcnt(6)
    v_mfma_f32_32x32x16_bf16 v[112:127], v[204:207], v[12:15], v[112:127]
    ds_read_b128 v[200:203], v233 offset:2048
    s_waitcnt lgkmcnt(6)
    v_mfma_f32_32x32x16_bf16 v[112:127], v[208:211], v[16:19], v[112:127]
    ds_read_b128 v[204:207], v233 offset:3072
    s_waitcnt lgkmcnt(6)
    v_mfma_f32_32x32x16_bf16 v[112:127], v[212:215], v[20:23], v[112:127]
    ds_read_b128 v[208:211], v233 offset:4096
    s_waitcnt lgkmcnt(6)
    v_mfma_f32_32x32x16_bf16 v[112:127], v[216:219], v[24:27], v[112:127]
    ds_read_b128 v[212:215], v233 offset:5120
    s_waitcnt lgkmcnt(6)
    v_mfma_f32_32x32x16_bf16 v[112:127], v[220:223], v[28:31], v[112:127]
    ds_read_b128 v[216:219], v233 offset:6144
    s_waitcnt lgkmcnt(6)
    v_mfma_f32_32x32x16_bf16 v[32:47], v[192:195], v[128:131], v[32:47]
    ds_read_b128 v[220:223], v233 offset:7168
    s_waitcnt lgkmcnt(6)
    v_mfma_f32_32x32x16_bf16 v[32:47], v[196:199], v[132:135], v[32:47]
    ds_read_b128 v[192:195], v233 offset:8192
    s_waitcnt lgkmcnt(6)
    v_mfma_f32_32x32x16_bf16 v[32:47], v[200:203], v[136:139], v[32:47]
    ds_read_b128 v[196:199], v233 offset:9216
    s_waitcnt lgkmcnt(6)
    v_mfma_f32_32x32x16_bf16 v[32:47], v[204:207], v[140:143], v[32:47]
    ds_read_b128 v[200:203], v233 offset:10240
    s_waitcnt lgkmcnt(6)
    v_mfma_f32_32x32x16_bf16 v[48:63], v[208:211], v[128:131], v[48:63]
    ds_read_b128 v[204:207], v233 offset:11264
    s_waitcnt lgkmcnt(6)
    v_mfma_f32_32x32x16_bf16 v[48:63], v[212:215], v[132:135], v[48:63]
    ds_read_b128 v[208:211], v233 offset:12288
    s_waitcnt lgkmcnt(6)
    v_mfma_f32_32x32x16_bf16 v[48:63], v[216:219], v[136:139], v[48:63]
    ds_read_b128 v[212:215], v233 offset:13312
    s_waitcnt lgkmcnt(6)
    v_mfma_f32_32x32x16_bf16 v[48:63], v[220:223], v[140:143], v[48:63]
    ds_read_b128 v[216:219], v233 offset:14336
    s_waitcnt lgkmcnt(6)
    v_mfma_f32_32x32x16_bf16 v[64:79], v[192:195], v[128:131], v[64:79]
    ds_read_b128 v[220:223], v233 offset:15360
    s_waitcnt lgkmcnt(6)
    v_mfma_f32_32x32x16_bf16 v[64:79], v[196:199], v[132:135], v[64:79]
    s_waitcnt lgkmcnt(5)
    v_mfma_f32_32x32x16_bf16 v[64:79], v[200:203], v[136:139], v[64:79]
    s_waitcnt lgkmcnt(4)
    v_mfma_f32_32x32x16_bf16 v[64:79], v[204:207], v[140:143], v[64:79]
    s_waitcnt lgkmcnt(3)
    v_mfma_f32_32x32x16_bf16 v[80:95], v[208:211], v[128:131], v[80:95]
    s_waitcnt lgkmcnt(2)
    v_mfma_f32_32x32x16_bf16 v[80:95], v[212:215], v[132:135], v[80:95]
    s_waitcnt lgkmcnt(1)
    v_mfma_f32_32x32x16_bf16 v[80:95], v[216:219], v[136:139], v[80:95]
    s_waitcnt lgkmcnt(0)
    v_mfma_f32_32x32x16_bf16 v[80:95], v[220:223], v[140:143], v[80:95]
    s_nop 11
L_k2_mdone:
    v_xor_b32 v232, 0x4000, v232
    v_xor_b32 v233, 0x4000, v233
    s_waitcnt vmcnt(4)
    s_barrier
    s_add_u32 s23, s14, 2
    s_and_b32 s36, s23, 1
    s_lshl_b32 s36, s36, 14
    s_add_u32 s45, s36, s20
    s_min_u32 s23, s23, 16
    s_cmp_ge_u32 s23, s12
    s_cselect_b32 s24, s12, 0
    s_sub_u32 s23, s23, s24
    s_lshl_b32 s23, s23, 15
    s_add_u32 s44, s23, s18
    s_add_u32 s23, s14, 1
    s_and_b32 s36, s23, 1
    s_lshl_b32 s36, s36, 14
    s_add_u32 s47, s36, s21
    s_min_u32 s23, s23, 16
    s_cmp_ge_u32 s23, s12
    s_cselect_b32 s24, s12, 0
    s_sub_u32 s23, s23, s24
    s_lshl_b32 s23, s23, 15
    s_add_u32 s46, s23, s19
    s_add_u32 s15, s15, 1
    s_cmp_lg_u32 s15, s16
    s_cbranch_scc1 L_k2_nomask
    s_cmp_eq_u32 s40, 1
    s_cbranch_scc1 L_k2_sskip
    v_cmp_lt_i32_e64 s[28:29], v242, 0
    v_cmp_lt_i32_e64 s[30:31], v242, 1
    v_cmp_lt_i32_e64 s[32:33], v242, 2
    v_cmp_lt_i32_e64 s[34:35], v242, 3
    v_cndmask_b32_e64 v96, v96, v245, s[28:29]
    v_cndmask_b32_e64 v97, v97, v245, s[30:31]
    v_cndmask_b32_e64 v98, v98, v245, s[32:33]
    v_cndmask_b32_e64 v99, v99, v245, s[34:35]
    v_cmp_lt_i32_e64 s[28:29], v242, 8
    v_cmp_lt_i32_e64 s[30:31], v242, 9
    v_cmp_lt_i32_e64 s[32:33], v242, 10
    v_cmp_lt_i32_e64 s[34:35], v242, 11
    v_cndmask_b32_e64 v100, v100, v245, s[28:29]
    v_cndmask_b32_e64 v101, v101, v245, s[30:31]
    v_cndmask_b32_e64 v102, v102, v245, s[32:33]
    v_cndmask_b32_e64 v103, v103, v245, s[34:35]
    v_cmp_lt_i32_e64 s[28:29], v242, 16
    v_cmp_lt_i32_e64 s[30:31], v242, 17
    v_cmp_lt_i32_e64 s[32:33], v242, 18
    v_cmp_lt_i32_e64 s[34:35], v242, 19
    v_cndmask_b32_e64 v104, v104, v245, s[28:29]
    v_cndmask_b32_e64 v105, v105, v245, s[30:31]
    v_cndmask_b32_e64 v106, v106, v245, s[32:33]
    v_cndmask_b32_e64 v107, v107, v245, s[34:35]
    v_cmp_lt_i32_e64 s[28:29], v242, 24
    v_cmp_lt_i32_e64 s[30:31], v242, 25
    v_cmp_lt_i32_e64 s[32:33], v242, 26
    v_cmp_lt_i32_e64 s[34:35], v242, 27
    v_cndmask_b32_e64 v108, v108, v245, s[28:29]
    v_cndmask_b32_e64 v109, v109, v245, s[30:31]
    v_cndmask_b32_e64 v110, v110, v245, s[32:33]
    v_cndmask_b32_e64 v111, v111, v245, s[34:35]
    v_cmp_lt_i32_e64 s[28:29], v242, 32
    v_cmp_lt_i32_e64 s[30:31], v242, 33
    v_cmp_lt_i32_e64 s[32:33], v242, 34
    v_cmp_lt_i32_e64 s[34:35], v242, 35
    v_cndmask_b32_e64 v112, v112, v245, s[28:29]
    v_cndmask_b32_e64 v113, v113, v245, s[30:31]
    v_cndmask_b32_e64 v114, v114, v245, s[32:33]
    v_cndmask_b32_e64 v115, v115, v245, s[34:35]
    v_cmp_lt_i32_e64 s[28:29], v242, 40
    v_cmp_lt_i32_e64 s[30:31], v242, 41
    v_cmp_lt_i32_e64 s[32:33], v242, 42
    v_cmp_lt_i32_e64 s[34:35], v242, 43
    v_cndmask_b32_e64 v116, v116, v245, s[28:29]
    v_cndmask_b32_e64 v117, v117, v245, s[30:31]
    v_cndmask_b32_e64 v118, v118, v245, s[32:33]
    v_cndmask_b32_e64 v119, v119, v245, s[34:35]
    v_cmp_lt_i32_e64 s[28:29], v242, 48
    v_cmp_lt_i32_e64 s[30:31], v242, 49
    v_cmp_lt_i32_e64 s[32:33], v242, 50
    v_cmp_lt_i32_e64 s[34:35], v242, 51
    v_cndmask_b32_e64 v120, v120, v245, s[28:29]
    v_cndmask_b32_e64 v121, v121, v245, s[30:31]
    v_cndmask_b32_e64 v122, v122, v245, s[32:33]
    v_cndmask_b32_e64 v123, v123, v245, s[34:35]
    v_cmp_lt_i32_e64 s[28:29], v242, 56
    v_cmp_lt_i32_e64 s[30:31], v242, 57
    v_cmp_lt_i32_e64 s[32:33], v242, 58
    v_cmp_lt_i32_e64 s[34:35], v242, 59
    v_cndmask_b32_e64 v124, v124, v245, s[28:29]
    v_cndmask_b32_e64 v125, v125, v245, s[30:31]
    v_cndmask_b32_e64 v126, v126, v245, s[32:33]
    v_cndmask_b32_e64 v127, v127, v245, s[34:35]
    s_nop 1
L_k2_nomask:
    s_mov_b32 s22, 0xf149f2ca
    s_cmp_eq_u32 s15, 1
    s_cbranch_scc1 L_k2_rare
L_k2_exp:
    v_exp_f32 v224, v96
    v_exp_f32 v225, v97
    s_mov_b32 m0, s45
    s_nop 0
    buffer_load_dwordx4 v234, s[8:11], s44 offen offset:0 lds
    v_exp_f32 v226, v98
    v_exp_f32 v227, v99
    v_cvt_pk_bf16_f32 v128, v224, v225
    v_add_f32 v238, v224, v225
    v_exp_f32 v228, v100
    v_exp_f32 v229, v101
    buffer_load_dwordx4 v234, s[8:11], s44 offen offset:1024 lds
    v_cvt_pk_bf16_f32 v129, v226, v227
    v_add_f32 v239, v226, v227
    v_exp_f32 v230, v102
    v_exp_f32 v231, v103
    v_cvt_pk_bf16_f32 v130, v228, v229
    v_add_f32 v238, v238, v228
    v_add_f32 v239, v239, v229
    v_exp_f32 v224, v104
    v_exp_f32 v225, v105
    buffer_load_dwordx4 v234, s[8:11], s44 offen offset:2048 lds
    v_cvt_pk_bf16_f32 v131, v230, v231
    v_add_f32 v238, v238, v230
    v_add_f32 v239, v239, v231
    v_exp_f32 v226, v106
    v_exp_f32 v227, v107
    v_cvt_pk_bf16_f32 v132, v224, v225
    v_add_f32 v238, v238, v224
    v_add_f32 v239, v239, v225
    v_exp_f32 v228, v108
    v_exp_f32 v229, v109
    buffer_load_dwordx4 v234, s[8:11], s44 offen offset:3072 lds
    v_cvt_pk_bf16_f32 v133, v226, v227
    v_add_f32 v238, v238, v226
    v_add_f32 v239, v239, v227
    v_exp_f32 v230, v110
    v_exp_f32 v231, v111
    v_cvt_pk_bf16_f32 v134, v228, v229
    v_add_f32 v238, v238, v228
    v_add_f32 v239, v239, v229
    v_exp_f32 v224, v112
    v_exp_f32 v225, v113
    s_mov_b32 m0, s47
    s_nop 0
    buffer_load_dwordx4 v234, s[8:11], s46 offen offset:0 lds
    v_cvt_pk_bf16_f32 v135, v230, v231
    v_add_f32 v238, v238, v230
    v_add_f32 v239, v239, v231
    v_exp_f32 v226, v114
    v_exp_f32 v227, v115
    v_cvt_pk_bf16_f32 v136, v224, v225
    v_add_f32 v238, v238, v224
    v_add_f32 v239, v239, v225
    v_exp_f32 v228, v116
    v_exp_f32 v229, v117
    buffer_load_dwordx4 v234, s[8:11], s46 offen offset:1024 lds
    v_cvt_pk_bf16_f32 v137, v226, v227
    v_add_f32 v238, v238, v226
    v_add_f32 v239, v239, v227
    v_exp_f32 v230, v118
    v_exp_f32 v231, v119
    v_cvt_pk_bf16_f32 v138, v228, v229
    v_add_f32 v238, v238, v228
    v_add_f32 v239, v239, v229
    v_exp_f32 v224, v120
    v_exp_f32 v225, v121
    buffer_load_dwordx4 v234, s[8:11], s46 offen offset:2048 lds
    v_cvt_pk_bf16_f32 v139, v230, v231
    v_add_f32 v238, v238, v230
    v_add_f32 v239, v239, v231
    v_exp_f32 v226, v122
    v_exp_f32 v227, v123
    v_cvt_pk_bf16_f32 v140, v224, v225
    v_add_f32 v238, v238, v224
    v_add_f32 v239, v239, v225
    v_exp_f32 v228, v124
    v_exp_f32 v229, v125
    buffer_load_dwordx4 v234, s[8:11], s46 offen offset:3072 lds
    v_cvt_pk_bf16_f32 v141, v226, v227
    v_add_f32 v238, v238, v226
    v_add_f32 v239, v239, v227
    v_exp_f32 v230, v126
    v_exp_f32 v231, v127
    v_cvt_pk_bf16_f32 v142, v228, v229
    v_add_f32 v238, v238, v228
    v_add_f32 v239, v239, v229
    v_cvt_pk_bf16_f32 v143, v230, v231
    v_add_f32 v238, v238, v230
    v_add_f32 v239, v239, v231
    v_add_f32 v243, v238, v239
    v_cmp_lt_f32 vcc, s26, v243
    s_mov_b32 s22, 0
    s_nop 2
    s_cbranch_vccnz L_k2_rare
L_k2_expdone:
    v_add_f32 v236, v236, v243
    s_add_u32 s14, s14, 1
    s_cmp_eq_u32 s15, s16
    s_cbranch_scc1 L_k2_last
    ds_read_b128 v[192:195], v232 offset:0
    ds_read_b128 v[196:199], v232 offset:1024
    ds_read_b128 v[200:203], v232 offset:2048
    ds_read_b128 v[204:207], v232 offset:3072
    ds_read_b128 v[208:211], v232 offset:4096
    ds_read_b128 v[212:215], v232 offset:5120
    s_waitcnt vmcnt(8)
    s_branch L_k2_loop
L_k2_rare:
    v_max3_f32 v243, v96, v97, v98
    v_max3_f32 v244, v99, v100, v101
    v_max3_f32 v243, v243, v102, v103
    v_max3_f32 v244, v244, v104, v105
    v_max3_f32 v243, v243, v106, v107
    v_max3_f32 v244, v244, v108, v109
    v_max3_f32 v243, v243, v110, v111
    v_max3_f32 v244, v244, v112, v113
    v_max3_f32 v243, v243, v114, v115
    v_max3_f32 v244, v244, v116, v117
    v_max3_f32 v243, v243, v118, v119
    v_max3_f32 v244, v244, v120, v121
    v_max3_f32 v243, v243, v122, v123
    v_max3_f32 v244, v244, v124, v125
    v_max3_f32 v243, v243, v126, v127
    v_max_f32 v243, v243, v244
    v_mov_b32 v244, v243
    s_nop 1
    v_permlane32_swap_b32 v243, v244
    v_max_f32 v243, v243, v244
    v_add_f32 v243, s27, v243
    v_max_f32 v243, s22, v243
    v_max_f32 v244, 0, v243
    v_sub_f32 v244, 0, v244
    v_exp_f32 v244, v244
    v_add_f32 v235, v235, v243
    v_sub_f32 v96, v96, v243
    v_sub_f32 v97, v97, v243
    v_sub_f32 v98, v98, v243
    v_sub_f32 v99, v99, v243
    v_sub_f32 v100, v100, v243
    v_sub_f32 v101, v101, v243
    v_sub_f32 v102, v102, v243
    v_sub_f32 v103, v103, v243
    v_sub_f32 v104, v104, v243
    v_sub_f32 v105, v105, v243
    v_sub_f32 v106, v106, v243
    v_sub_f32 v107, v107, v243
    v_sub_f32 v108, v108, v243
    v_sub_f32 v109, v109, v243
    v_sub_f32 v110, v110, v243
    v_sub_f32 v111, v111, v243
    v_sub_f32 v112, v112, v243
    v_sub_f32 v113, v113, v243
    v_sub_f32 v114, v114, v243
    v_sub_f32 v115, v115, v243
    v_sub_f32 v116, v116, v243
    v_sub_f32 v117, v117, v243
    v_sub_f32 v118, v118, v243
    v_sub_f32 v119, v119, v243
    v_sub_f32 v120, v120, v243
    v_sub_f32 v121, v121, v243
    v_sub_f32 v122, v122, v243
    v_sub_f32 v123, v123, v243
    v_sub_f32 v124, v124, v243
    v_sub_f32 v125, v125, v243
    v_sub_f32 v126, v126, v243
    v_sub_f32 v127, v127, v243
    v_sub_f32 v144, s38, v235
    v_sub_f32 v145, s38, v235
    v_sub_f32 v146, s38, v235
    v_sub_f32 v147, s38, v235
    v_sub_f32 v148, s38, v235
    v_sub_f32 v149, s38, v235
    v_sub_f32 v150, s38, v235
    v_sub_f32 v151, s38, v235
    v_sub_f32 v152, s38, v235
    v_sub_f32 v153, s38, v235
    v_sub_f32 v154, s38, v235
    v_sub_f32 v155, s38, v235
    v_sub_f32 v156, s38, v235
    v_sub_f32 v157, s38, v235
    v_sub_f32 v158, s38, v235
    v_sub_f32 v159, s38, v235
    s_cmp_lg_u32 s22, 0
    s_cbranch_scc1 L_k2_exp
    v_mul_f32 v236, v236, v244
    v_mul_f32 v32, v32, v244
    v_mul_f32 v33, v33, v244
    v_mul_f32 v34, v34, v244
    v_mul_f32 v35, v35, v244
    v_mul_f32 v36, v36, v244
    v_mul_f32 v37, v37, v244
    v_mul_f32 v38, v38, v244
    v_mul_f32 v39, v39, v244
    v_mul_f32 v40, v40, v244
    v_mul_f32 v41, v41, v244
    v_mul_f32 v42, v42, v244
    v_mul_f32 v43, v43, v244
    v_mul_f32 v44, v44, v244
    v_mul_f32 v45, v45, v244
    v_mul_f32 v46, v46, v244
    v_mul_f32 v47, v47, v244
    v_mul_f32 v48, v48, v244
    v_mul_f32 v49, v49, v244
    v_mul_f32 v50, v50, v244
    v_mul_f32 v51, v51, v244
    v_mul_f32 v52, v52, v244
    v_mul_f32 v53, v53, v244
    v_mul_f32 v54, v54, v244
    v_mul_f32 v55, v55, v244
    v_mul_f32 v56, v56, v244
    v_mul_f32 v57, v57, v244
    v_mul_f32 v58, v58, v244
    v_mul_f32 v59, v59, v244
    v_mul_f32 v60, v60, v244
    v_mul_f32 v61, v61, v244
    v_mul_f32 v62, v62, v244
    v_mul_f32 v63, v63, v244
    v_mul_f32 v64, v64, v244
    v_mul_f32 v65, v65, v244
    v_mul_f32 v66, v66, v244
    v_mul_f32 v67, v67, v244
    v_mul_f32 v68, v68, v244
    v_mul_f32 v69, v69, v244
    v_mul_f32 v70, v70, v244
    v_mul_f32 v71, v71, v244
    v_mul_f32 v72, v72, v244
    v_mul_f32 v73, v73, v244
    v_mul_f32 v74, v74, v244
    v_mul_f32 v75, v75, v244
    v_mul_f32 v76, v76, v244
    v_mul_f32 v77, v77, v244
    v_mul_f32 v78, v78, v244
    v_mul_f32 v79, v79, v244
    v_mul_f32 v80, v80, v244
    v_mul_f32 v81, v81, v244
    v_mul_f32 v82, v82, v244
    v_mul_f32 v83, v83, v244
    v_mul_f32 v84, v84, v244
    v_mul_f32 v85, v85, v244
    v_mul_f32 v86, v86, v244
    v_mul_f32 v87, v87, v244
    v_mul_f32 v88, v88, v244
    v_mul_f32 v89, v89, v244
    v_mul_f32 v90, v90, v244
    v_mul_f32 v91, v91, v244
    v_mul_f32 v92, v92, v244
    v_mul_f32 v93, v93, v244
    v_mul_f32 v94, v94, v244
    v_mul_f32 v95, v95, v244
    v_exp_f32 v224, v96
    v_exp_f32 v225, v97
    v_exp_f32 v226, v98
    v_exp_f32 v227, v99
    v_cvt_pk_bf16_f32 v128, v224, v225
    v_add_f32 v238, v224, v225
    v_exp_f32 v228, v100
    v_exp_f32 v229, v101
    v_cvt_pk_bf16_f32 v129, v226, v227
    v_add_f32 v239, v226, v227
    v_exp_f32 v230, v102
    v_exp_f32 v231, v103
    v_cvt_pk_bf16_f32 v130, v228, v229
    v_add_f32 v238, v238, v228
    v_add_f32 v239, v239, v229
    v_exp_f32 v224, v104
    v_exp_f32 v225, v105
    v_cvt_pk_bf16_f32 v131, v230, v231
    v_add_f32 v238, v238, v230
    v_add_f32 v239, v239, v231
    v_exp_f32 v226, v106
    v_exp_f32 v227, v107
    v_cvt_pk_bf16_f32 v132, v224, v225
    v_add_f32 v238, v238, v224
    v_add_f32 v239, v239, v225
    v_exp_f32 v228, v108
    v_exp_f32 v229, v109
    v_cvt_pk_bf16_f32 v133, v226, v227
    v_add_f32 v238, v238, v226
    v_add_f32 v239, v239, v227
    v_exp_f32 v230, v110
    v_exp_f32 v231, v111
    v_cvt_pk_bf16_f32 v134, v228, v229
    v_add_f32 v238, v238, v228
    v_add_f32 v239, v239, v229
    v_exp_f32 v224, v112
    v_exp_f32 v225, v113
    v_cvt_pk_bf16_f32 v135, v230, v231
    v_add_f32 v238, v238, v230
    v_add_f32 v239, v239, v231
    v_exp_f32 v226, v114
    v_exp_f32 v227, v115
    v_cvt_pk_bf16_f32 v136, v224, v225
    v_add_f32 v238, v238, v224
    v_add_f32 v239, v239, v225
    v_exp_f32 v228, v116
    v_exp_f32 v229, v117
    v_cvt_pk_bf16_f32 v137, v226, v227
    v_add_f32 v238, v238, v226
    v_add_f32 v239, v239, v227
    v_exp_f32 v230, v118
    v_exp_f32 v231, v119
    v_cvt_pk_bf16_f32 v138, v228, v229
    v_add_f32 v238, v238, v228
    v_add_f32 v239, v239, v229
    v_exp_f32 v224, v120
    v_exp_f32 v225, v121
    v_cvt_pk_bf16_f32 v139, v230, v231
    v_add_f32 v238, v238, v230
    v_add_f32 v239, v239, v231
    v_exp_f32 v226, v122
    v_exp_f32 v227, v123
    v_cvt_pk_bf16_f32 v140, v224, v225
    v_add_f32 v238, v238, v224
    v_add_f32 v239, v239, v225
    v_exp_f32 v228, v124
    v_exp_f32 v229, v125
    v_cvt_pk_bf16_f32 v141, v226, v227
    v_add_f32 v238, v238, v226
    v_add_f32 v239, v239, v227
    v_exp_f32 v230, v126
    v_exp_f32 v231, v127
    v_cvt_pk_bf16_f32 v142, v228, v229
    v_add_f32 v238, v238, v228
    v_add_f32 v239, v239, v229
    v_cvt_pk_bf16_f32 v143, v230, v231
    v_add_f32 v238, v238, v230
    v_add_f32 v239, v239, v231
    v_add_f32 v243, v238, v239
    s_nop 0
    s_branch L_k2_expdone
L_k2_sskip:
    s_mov_b32 m0, s45
    s_nop 0
    buffer_load_dwordx4 v234, s[8:11], s44 offen offset:0 lds
    buffer_load_dwordx4 v234, s[8:11], s44 offen offset:1024 lds
    buffer_load_dwordx4 v234, s[8:11], s44 offen offset:2048 lds
    buffer_load_dwordx4 v234, s[8:11], s44 offen offset:3072 lds
    s_mov_b32 m0, s47
    s_nop 0
    buffer_load_dwordx4 v234, s[8:11], s46 offen offset:0 lds
    buffer_load_dwordx4 v234, s[8:11], s46 offen offset:1024 lds
    buffer_load_dwordx4 v234, s[8:11], s46 offen offset:2048 lds
    buffer_load_dwordx4 v234, s[8:11], s46 offen offset:3072 lds
    s_cmp_lg_u32 s16, 1
    s_cbranch_scc1 L_k2_sskip2
    v_mov_b32 v235, 0xf149f2ca
    s_nop 1
L_k2_sskip2:
    s_add_u32 s14, s14, 1
    s_waitcnt vmcnt(8)
    s_barrier
    s_branch L_k2_lastdone
L_k2_last:
    s_waitcnt vmcnt(8)
    s_barrier
    ds_read_b128 v[192:195], v233 offset:0
    ds_read_b128 v[196:199], v233 offset:1024
    ds_read_b128 v[200:203], v233 offset:2048
    ds_read_b128 v[204:207], v233 offset:3072
    ds_read_b128 v[208:211], v233 offset:4096
    ds_read_b128 v[212:215], v233 offset:5120
    ds_read_b128 v[216:219], v233 offset:6144
    s_waitcnt lgkmcnt(6)
    v_mfma_f32_32x32x16_bf16 v[32:47], v[192:195], v[128:131], v[32:47]
    ds_read_b128 v[220:223], v233 offset:7168
    s_waitcnt lgkmcnt(6)
    v_mfma_f32_32x32x16_bf16 v[32:47], v[196:199], v[132:135], v[32:47]
    ds_read_b128 v[192:195], v233 offset:8192
    s_waitcnt lgkmcnt(6)
    v_mfma_f32_32x32x16_bf16 v[32:47], v[200:203], v[136:139], v[32:47]
    ds_read_b128 v[196:199], v233 offset:9216
    s_waitcnt lgkmcnt(6)
    v_mfma_f32_32x32x16_bf16 v[32:47], v[204:207], v[140:143], v[32:47]
    ds_read_b128 v[200:203], v233 offset:10240
    s_waitcnt lgkmcnt(6)
    v_mfma_f32_32x32x16_bf16 v[48:63], v[208:211], v[128:131], v[48:63]
    ds_read_b128 v[204:207], v233 offset:11264
    s_waitcnt lgkmcnt(6)
    v_mfma_f32_32x32x16_bf16 v[48:63], v[212:215], v[132:135], v[48:63]
    ds_read_b128 v[208:211], v233 offset:12288
    s_waitcnt lgkmcnt(6)
    v_mfma_f32_32x32x16_bf16 v[48:63], v[216:219], v[136:139], v[48:63]
    ds_read_b128 v[212:215], v233 offset:13312
    s_waitcnt lgkmcnt(6)
    v_mfma_f32_32x32x16_bf16 v[48:63], v[220:223], v[140:143], v[48:63]
    ds_read_b128 v[216:219], v233 offset:14336
    s_waitcnt lgkmcnt(6)
    v_mfma_f32_32x32x16_bf16 v[64:79], v[192:195], v[128:131], v[64:79]
    ds_read_b128 v[220:223], v233 offset:15360
    s_waitcnt lgkmcnt(6)
    v_mfma_f32_32x32x16_bf16 v[64:79], v[196:199], v[132:135], v[64:79]
    s_waitcnt lgkmcnt(5)
    v_mfma_f32_32x32x16_bf16 v[64:79], v[200:203], v[136:139], v[64:79]
    s_waitcnt lgkmcnt(4)
    v_mfma_f32_32x32x16_bf16 v[64:79], v[204:207], v[140:143], v[64:79]
    s_waitcnt lgkmcnt(3)
    v_mfma_f32_32x32x16_bf16 v[80:95], v[208:211], v[128:131], v[80:95]
    s_waitcnt lgkmcnt(2)
    v_mfma_f32_32x32x16_bf16 v[80:95], v[212:215], v[132:135], v[80:95]
    s_waitcnt lgkmcnt(1)
    v_mfma_f32_32x32x16_bf16 v[80:95], v[216:219], v[136:139], v[80:95]
    s_waitcnt lgkmcnt(0)
    v_mfma_f32_32x32x16_bf16 v[80:95], v[220:223], v[140:143], v[80:95]
    s_nop 11
L_k2_lastdone:
    v_sub_u32 v250, v233, v234
    v_lshrrev_b32 v243, 2, v234
    v_add_u32 v250, v250, v243
    s_lshl_b32 s23, s7, 9
    v_add_u32 v250, s23, v250
    v_xor_b32 v233, 0x4000, v233
    v_xor_b32 v233, 0x4000, v233
    v_mov_b32 v243, v236
    s_nop 1
    v_permlane32_swap_b32 v236, v243
    v_add_f32 v236, v236, v243
    v_xor_b32 v249, 0x10000, v250
    s_lshl_b32 s37, s17, 2
    s_add_u32 s37, s37, s7
    s_lshl_b32 s37, s37, 8
    s_lshl_b32 s23, s4, 3
    s_add_u32 s37, s37, s23
    s_lshl_b32 s37, s37, 10
    s_add_u32 s37, s37, 0x3000000
    s_mov_b32 s17, s5
    s_barrier
    s_lshl_b32 s23, s4, 6
    s_lshl_b32 s24, s17, 2
    s_add_u32 s23, s23, s24
    s_add_u32 s23, s23, s7
    s_lshl_b32 s23, s23, 13
    s_add_u32 s24, s23, 4096
    buffer_load_dwordx4 v[0:3], v234, s[8:11], s23 offen offset:0
    buffer_load_dwordx4 v[4:7], v234, s[8:11], s23 offen offset:1024
    buffer_load_dwordx4 v[8:11], v234, s[8:11], s23 offen offset:2048
    buffer_load_dwordx4 v[12:15], v234, s[8:11], s23 offen offset:3072
    buffer_load_dwordx4 v[16:19], v234, s[8:11], s24 offen offset:0
    buffer_load_dwordx4 v[20:23], v234, s[8:11], s24 offen offset:1024
    buffer_load_dwordx4 v[24:27], v234, s[8:11], s24 offen offset:2048
    buffer_load_dwordx4 v[28:31], v234, s[8:11], s24 offen offset:3072
    s_cmp_eq_u32 s6, 0
    s_cbranch_scc0 L_k2_mergeB
    ds_write_b32 v250, v235
    ds_write_b32 v250, v236 offset:256
    ds_write_b128 v246, v[64:67] offset:0
    ds_write_b128 v246, v[68:71] offset:1024
    ds_write_b128 v246, v[72:75] offset:2048
    ds_write_b128 v246, v[76:79] offset:3072
    ds_write_b128 v246, v[80:83] offset:4096
    ds_write_b128 v246, v[84:87] offset:5120
    ds_write_b128 v246, v[88:91] offset:6144
    ds_write_b128 v246, v[92:95] offset:7168
    s_waitcnt lgkmcnt(0)
    s_barrier
    s_barrier
    ds_read_b32 v247, v249
    ds_read_b32 v248, v249 offset:256
    ds_read_b128 v[160:163], v246 offset:0
    ds_read_b128 v[164:167], v246 offset:1024
    ds_read_b128 v[168:171], v246 offset:2048
    ds_read_b128 v[172:175], v246 offset:3072
    ds_read_b128 v[176:179], v246 offset:4096
    ds_read_b128 v[180:183], v246 offset:5120
    ds_read_b128 v[184:187], v246 offset:6144
    ds_read_b128 v[188:191], v246 offset:7168
    s_waitcnt lgkmcnt(0)
    v_max_f32 v243, v235, v247
    v_sub_f32 v244, v235, v243
    v_sub_f32 v247, v247, v243
    v_exp_f32 v244, v244
    v_exp_f32 v247, v247
    v_mul_f32 v243, v244, v236
    v_fmac_f32 v243, v247, v248
    v_rcp_f32 v243, v243
    s_nop 0
    v_mul_f32 v243, s39, v243
    v_mul_f32 v244, v244, v243
    v_mul_f32 v247, v247, v243
    v_mul_f32 v32, v32, v244
    v_fmac_f32 v32, v160, v247
    v_mul_f32 v33, v33, v244
    v_fmac_f32 v33, v161, v247
    v_mul_f32 v34, v34, v244
    v_fmac_f32 v34, v162, v247
    v_mul_f32 v35, v35, v244
    v_fmac_f32 v35, v163, v247
    v_mul_f32 v36, v36, v244
    v_fmac_f32 v36, v164, v247
    v_mul_f32 v37, v37, v244
    v_fmac_f32 v37, v165, v247
    v_mul_f32 v38, v38, v244
    v_fmac_f32 v38, v166, v247
    v_mul_f32 v39, v39, v244
    v_fmac_f32 v39, v167, v247
    v_mul_f32 v40, v40, v244
    v_fmac_f32 v40, v168, v247
    v_mul_f32 v41, v41, v244
    v_fmac_f32 v41, v169, v247
    v_mul_f32 v42, v42, v244
    v_fmac_f32 v42, v170, v247
    v_mul_f32 v43, v43, v244
    v_fmac_f32 v43, v171, v247
    v_mul_f32 v44, v44, v244
    v_fmac_f32 v44, v172, v247
    v_mul_f32 v45, v45, v244
    v_fmac_f32 v45, v173, v247
    v_mul_f32 v46, v46, v244
    v_fmac_f32 v46, v174, v247
    v_mul_f32 v47, v47, v244
    v_fmac_f32 v47, v175, v247
    v_mul_f32 v48, v48, v244
    v_fmac_f32 v48, v176, v247
    v_mul_f32 v49, v49, v244
    v_fmac_f32 v49, v177, v247
    v_mul_f32 v50, v50, v244
    v_fmac_f32 v50, v178, v247
    v_mul_f32 v51, v51, v244
    v_fmac_f32 v51, v179, v247
    v_mul_f32 v52, v52, v244
    v_fmac_f32 v52, v180, v247
    v_mul_f32 v53, v53, v244
    v_fmac_f32 v53, v181, v247
    v_mul_f32 v54, v54, v244
    v_fmac_f32 v54, v182, v247
    v_mul_f32 v55, v55, v244
    v_fmac_f32 v55, v183, v247
    v_mul_f32 v56, v56, v244
    v_fmac_f32 v56, v184, v247
    v_mul_f32 v57, v57, v244
    v_fmac_f32 v57, v185, v247
    v_mul_f32 v58, v58, v244
    v_fmac_f32 v58, v186, v247
    v_mul_f32 v59, v59, v244
    v_fmac_f32 v59, v187, v247
    v_mul_f32 v60, v60, v244
    v_fmac_f32 v60, v188, v247
    v_mul_f32 v61, v61, v244
    v_fmac_f32 v61, v189, v247
    v_mul_f32 v62, v62, v244
    v_fmac_f32 v62, v190, v247
    v_mul_f32 v63, v63, v244
    v_fmac_f32 v63, v191, v247
    v_cvt_pk_bf16_f32 v32, v32, v33
    v_cvt_pk_bf16_f32 v33, v34, v35
    v_cvt_pk_bf16_f32 v34, v36, v37
    v_cvt_pk_bf16_f32 v35, v38, v39
    buffer_store_dwordx4 v[32:35], v234, s[8:11], s37 offen offset:0 sc1
    v_cvt_pk_bf16_f32 v40, v40, v41
    v_cvt_pk_bf16_f32 v41, v42, v43
    v_cvt_pk_bf16_f32 v42, v44, v45
    v_cvt_pk_bf16_f32 v43, v46, v47
    buffer_store_dwordx4 v[40:43], v234, s[8:11], s37 offen offset:1024 sc1
    v_cvt_pk_bf16_f32 v48, v48, v49
    v_cvt_pk_bf16_f32 v49, v50, v51
    v_cvt_pk_bf16_f32 v50, v52, v53
    v_cvt_pk_bf16_f32 v51, v54, v55
    buffer_store_dwordx4 v[48:51], v234, s[8:11], s37 offen offset:2048 sc1
    v_cvt_pk_bf16_f32 v56, v56, v57
    v_cvt_pk_bf16_f32 v57, v58, v59
    v_cvt_pk_bf16_f32 v58, v60, v61
    v_cvt_pk_bf16_f32 v59, v62, v63
    buffer_store_dwordx4 v[56:59], v234, s[8:11], s37 offen offset:3072 sc1
    s_nop 0
    s_branch L_k2_next
L_k2_mergeB:
    ds_write_b32 v250, v235
    ds_write_b32 v250, v236 offset:256
    ds_read_b32 v247, v249
    ds_read_b32 v248, v249 offset:256
    ds_read_b128 v[160:163], v246 offset:0
    ds_read_b128 v[164:167], v246 offset:1024
    ds_read_b128 v[168:171], v246 offset:2048
    ds_read_b128 v[172:175], v246 offset:3072
    ds_read_b128 v[176:179], v246 offset:4096
    ds_read_b128 v[180:183], v246 offset:5120
    ds_read_b128 v[184:187], v246 offset:6144
    ds_read_b128 v[188:191], v246 offset:7168
    s_waitcnt lgkmcnt(0)
    ds_write_b128 v246, v[32:35] offset:0
    ds_write_b128 v246, v[36:39] offset:1024
    ds_write_b128 v246, v[40:43] offset:2048
    ds_write_b128 v246, v[44:47] offset:3072
    ds_write_b128 v246, v[48:51] offset:4096
    ds_write_b128 v246, v[52:55] offset:5120
    ds_write_b128 v246, v[56:59] offset:6144
    ds_write_b128 v246, v[60:63] offset:7168
    s_waitcnt lgkmcnt(0)
    s_barrier
    v_max_f32 v243, v235, v247
    v_sub_f32 v244, v235, v243
    v_sub_f32 v247, v247, v243
    v_exp_f32 v244, v244
    v_exp_f32 v247, v247
    v_mul_f32 v243, v244, v236
    v_fmac_f32 v243, v247, v248
    v_rcp_f32 v243, v243
    s_nop 0
    v_mul_f32 v243, s39, v243
    v_mul_f32 v244, v244, v243
    v_mul_f32 v247, v247, v243
    v_mul_f32 v64, v64, v244
    v_fmac_f32 v64, v160, v247
    v_mul_f32 v65, v65, v244
    v_fmac_f32 v65, v161, v247
    v_mul_f32 v66, v66, v244
    v_fmac_f32 v66, v162, v247
    v_mul_f32 v67, v67, v244
    v_fmac_f32 v67, v163, v247
    v_mul_f32 v68, v68, v244
    v_fmac_f32 v68, v164, v247
    v_mul_f32 v69, v69, v244
    v_fmac_f32 v69, v165, v247
    v_mul_f32 v70, v70, v244
    v_fmac_f32 v70, v166, v247
    v_mul_f32 v71, v71, v244
    v_fmac_f32 v71, v167, v247
    v_mul_f32 v72, v72, v244
    v_fmac_f32 v72, v168, v247
    v_mul_f32 v73, v73, v244
    v_fmac_f32 v73, v169, v247
    v_mul_f32 v74, v74, v244
    v_fmac_f32 v74, v170, v247
    v_mul_f32 v75, v75, v244
    v_fmac_f32 v75, v171, v247
    v_mul_f32 v76, v76, v244
    v_fmac_f32 v76, v172, v247
    v_mul_f32 v77, v77, v244
    v_fmac_f32 v77, v173, v247
    v_mul_f32 v78, v78, v244
    v_fmac_f32 v78, v174, v247
    v_mul_f32 v79, v79, v244
    v_fmac_f32 v79, v175, v247
    v_mul_f32 v80, v80, v244
    v_fmac_f32 v80, v176, v247
    v_mul_f32 v81, v81, v244
    v_fmac_f32 v81, v177, v247
    v_mul_f32 v82, v82, v244
    v_fmac_f32 v82, v178, v247
    v_mul_f32 v83, v83, v244
    v_fmac_f32 v83, v179, v247
    v_mul_f32 v84, v84, v244
    v_fmac_f32 v84, v180, v247
    v_mul_f32 v85, v85, v244
    v_fmac_f32 v85, v181, v247
    v_mul_f32 v86, v86, v244
    v_fmac_f32 v86, v182, v247
    v_mul_f32 v87, v87, v244
    v_fmac_f32 v87, v183, v247
    v_mul_f32 v88, v88, v244
    v_fmac_f32 v88, v184, v247
    v_mul_f32 v89, v89, v244
    v_fmac_f32 v89, v185, v247
    v_mul_f32 v90, v90, v244
    v_fmac_f32 v90, v186, v247
    v_mul_f32 v91, v91, v244
    v_fmac_f32 v91, v187, v247
    v_mul_f32 v92, v92, v244
    v_fmac_f32 v92, v188, v247
    v_mul_f32 v93, v93, v244
    v_fmac_f32 v93, v189, v247
    v_mul_f32 v94, v94, v244
    v_fmac_f32 v94, v190, v247
    v_mul_f32 v95, v95, v244
    v_fmac_f32 v95, v191, v247
    v_cvt_pk_bf16_f32 v64, v64, v65
    v_cvt_pk_bf16_f32 v65, v66, v67
    v_cvt_pk_bf16_f32 v66, v68, v69
    v_cvt_pk_bf16_f32 v67, v70, v71
    s_add_u32 s37, s37, 4096
    buffer_store_dwordx4 v[64:67], v234, s[8:11], s37 offen offset:0 sc1
    v_cvt_pk_bf16_f32 v72, v72, v73
    v_cvt_pk_bf16_f32 v73, v74, v75
    v_cvt_pk_bf16_f32 v74, v76, v77
    v_cvt_pk_bf16_f32 v75, v78, v79
    buffer_store_dwordx4 v[72:75], v234, s[8:11], s37 offen offset:1024 sc1
    v_cvt_pk_bf16_f32 v80, v80, v81
    v_cvt_pk_bf16_f32 v81, v82, v83
    v_cvt_pk_bf16_f32 v82, v84, v85
    v_cvt_pk_bf16_f32 v83, v86, v87
    buffer_store_dwordx4 v[80:83], v234, s[8:11], s37 offen offset:2048 sc1
    v_cvt_pk_bf16_f32 v88, v88, v89
    v_cvt_pk_bf16_f32 v89, v90, v91
    v_cvt_pk_bf16_f32 v90, v92, v93
    v_cvt_pk_bf16_f32 v91, v94, v95
    buffer_store_dwordx4 v[88:91], v234, s[8:11], s37 offen offset:3072 sc1
    s_nop 1
L_k2_next:
    s_add_u32 s25, s25, 1
    s_cmp_eq_u32 s25, 2
    s_cbranch_scc1 L_k2_end
    s_waitcnt vmcnt(4)
    s_branch L_k2_qblock
L_k2_end:
    s_endpgm
.globl k3_out_kernel
.p2align 8
.type k3_out_kernel,@function
k3_out_kernel:
    s_cmp_ge_u32 s2, 512
    s_cbranch_scc1 L_k34_end
    s_and_b32 s60, s2, 255
    s_cmp_ge_u32 s2, 256
    s_cbranch_scc1 L_k34_second
    s_setprio 2
    s_load_dwordx4 s[32:35], s[0:1], 48
    s_load_dwordx4 s[36:39], s[0:1], 64
    s_load_dwordx4 s[40:43], s[0:1], 80
    s_load_dwordx4 s[44:47], s[0:1], 96
    s_load_dwordx4 s[48:51], s[0:1], 112
    s_load_dwordx2 s[52:53], s[0:1], 136
    v_lshrrev_b32 v2, 6, v0
    s_nop 0
    v_readfirstlane_b32 s3, v2
    v_and_b32 v1, 63, v0
    s_and_b32 s59, s60, 7
    s_lshl_b32 s59, s59, 5
    s_lshr_b32 s4, s60, 3
    s_add_u32 s59, s59, s4
    s_lshl_b32 s4, s59, 2
    s_waitcnt lgkmcnt(0)
    s_load_dword s5, s[46:47], s4
    s_load_dword s6, s[48:49], s4
    s_mov_b32 s8, s52
    s_and_b32 s9, s53, 0xffff
    s_mov_b32 s10, 0x4800000
    s_mov_b32 s11, 0x20000
    s_mov_b32 s12, s50
    s_and_b32 s13, s51, 0xffff
    s_mov_b32 s14, 0x400000
    s_mov_b32 s15, 0x20000
    v_mov_b32 v16, 0
    v_mov_b32 v17, 0
    v_mov_b32 v18, 0
    v_mov_b32 v19, 0
    s_cmp_ge_u32 s3, 4
    s_cbranch_scc1 L_ssm_nopar0
    v_lshlrev_b32 v3, 1, v0
    s_lshl_b32 s7, s59, 9
    s_mov_b32 s16, s34
    s_and_b32 s17, s35, 0xffff
    s_mov_b32 s18, 0x20000
    s_mov_b32 s19, 0x20000
    buffer_load_ushort v20, v3, s[16:19], s7 offen
    s_mov_b32 s16, s36
    s_and_b32 s17, s37, 0xffff
    s_mov_b32 s18, 0x20000
    s_mov_b32 s19, 0x20000
    buffer_load_ushort v21, v3, s[16:19], s7 offen
    s_mov_b32 s16, s38
    s_and_b32 s17, s39, 0xffff
    s_mov_b32 s18, 0x20000
    s_mov_b32 s19, 0x20000
    buffer_load_ushort v22, v3, s[16:19], s7 offen
    s_mov_b32 s16, s40
    s_and_b32 s17, s41, 0xffff
    s_mov_b32 s18, 0x20000
    s_mov_b32 s19, 0x20000
    buffer_load_ushort v23, v3, s[16:19], s7 offen
    s_mov_b32 s16, s42
    s_and_b32 s17, s43, 0xffff
    s_mov_b32 s18, 0x20000
    s_mov_b32 s19, 0x20000
    buffer_load_ushort v24, v3, s[16:19], s7 offen
    s_mov_b32 s16, s44
    s_and_b32 s17, s45, 0xffff
    s_mov_b32 s18, 0x20000
    s_mov_b32 s19, 0x20000
    buffer_load_ushort v25, v3, s[16:19], s7 offen
L_ssm_nopar0:
    v_lshlrev_b32 v2, 2, v0
    s_lshl_b32 s7, s59, 13
    s_add_u32 s7, s7, 0x4400000
    buffer_load_dword v8, v2, s[8:11], s7 offen offset:0
    buffer_load_dword v9, v2, s[8:11], s7 offen offset:2048
    s_add_u32 s7, s7, 4096
    buffer_load_dword v10, v2, s[8:11], s7 offen offset:0
    buffer_load_dword v11, v2, s[8:11], s7 offen offset:2048
    v_and_b32 v3, 255, v0
    v_lshrrev_b32 v2, 8, v0
    v_mul_u32_u24 v4, 12288, v2
    v_lshl_add_u32 v80, v3, 3, 0
    v_cvt_f32_u32 v80, v80
    v_cvt_pk_bf16_f32 v80, v80, v80
    v_lshlrev_b32 v80, 16, v80
    v_cvt_u32_f32 v40, v80
    v_lshrrev_b32 v80, 23, v80
    v_subrev_u32 v80, 134, v80
    v_med3_i32 v80, v80, 0, 3
    v_lshrrev_b32 v48, 7, v40
    v_lshlrev_b32 v48, 3, v48
    v_and_or_b32 v48, v40, 7, v48
    v_lshrrev_b32 v48, v80, v48
    v_lshl_add_u32 v48, v80, 3, v48
    v_bfe_u32 v40, v40, 3, 4
    v_lshl_add_u32 v48, v48, 4, v40
    v_lshl_add_u32 v80, v48, 2, v4
    v_lshl_add_u32 v81, v3, 3, 1
    v_cvt_f32_u32 v81, v81
    v_cvt_pk_bf16_f32 v81, v81, v81
    v_lshlrev_b32 v81, 16, v81
    v_cvt_u32_f32 v41, v81
    v_lshrrev_b32 v81, 23, v81
    v_subrev_u32 v81, 134, v81
    v_med3_i32 v81, v81, 0, 3
    v_lshrrev_b32 v49, 7, v41
    v_lshlrev_b32 v49, 3, v49
    v_and_or_b32 v49, v41, 7, v49
    v_lshrrev_b32 v49, v81, v49
    v_lshl_add_u32 v49, v81, 3, v49
    v_bfe_u32 v41, v41, 3, 4
    v_lshl_add_u32 v49, v49, 4, v41
    v_lshl_add_u32 v81, v49, 2, v4
    v_lshl_add_u32 v82, v3, 3, 2
    v_cvt_f32_u32 v82, v82
    v_cvt_pk_bf16_f32 v82, v82, v82
    v_lshlrev_b32 v82, 16, v82
    v_cvt_u32_f32 v42, v82
    v_lshrrev_b32 v82, 23, v82
    v_subrev_u32 v82, 134, v82
    v_med3_i32 v82, v82, 0, 3
    v_lshrrev_b32 v50, 7, v42
    v_lshlrev_b32 v50, 3, v50
    v_and_or_b32 v50, v42, 7, v50
    v_lshrrev_b32 v50, v82, v50
    v_lshl_add_u32 v50, v82, 3, v50
    v_bfe_u32 v42, v42, 3, 4
    v_lshl_add_u32 v50, v50, 4, v42
    v_lshl_add_u32 v82, v50, 2, v4
    v_lshl_add_u32 v83, v3, 3, 3
    v_cvt_f32_u32 v83, v83
    v_cvt_pk_bf16_f32 v83, v83, v83
    v_lshlrev_b32 v83, 16, v83
    v_cvt_u32_f32 v43, v83
    v_lshrrev_b32 v83, 23, v83
    v_subrev_u32 v83, 134, v83
    v_med3_i32 v83, v83, 0, 3
    v_lshrrev_b32 v51, 7, v43
    v_lshlrev_b32 v51, 3, v51
    v_and_or_b32 v51, v43, 7, v51
    v_lshrrev_b32 v51, v83, v51
    v_lshl_add_u32 v51, v83, 3, v51
    v_bfe_u32 v43, v43, 3, 4
    v_lshl_add_u32 v51, v51, 4, v43
    v_lshl_add_u32 v83, v51, 2, v4
    v_lshl_add_u32 v84, v3, 3, 4
    v_cvt_f32_u32 v84, v84
    v_cvt_pk_bf16_f32 v84, v84, v84
    v_lshlrev_b32 v84, 16, v84
    v_cvt_u32_f32 v44, v84
    v_lshrrev_b32 v84, 23, v84
    v_subrev_u32 v84, 134, v84
    v_med3_i32 v84, v84, 0, 3
    v_lshrrev_b32 v52, 7, v44
    v_lshlrev_b32 v52, 3, v52
    v_and_or_b32 v52, v44, 7, v52
    v_lshrrev_b32 v52, v84, v52
    v_lshl_add_u32 v52, v84, 3, v52
    v_bfe_u32 v44, v44, 3, 4
    v_lshl_add_u32 v52, v52, 4, v44
    v_lshl_add_u32 v84, v52, 2, v4
    v_lshl_add_u32 v85, v3, 3, 5
    v_cvt_f32_u32 v85, v85
    v_cvt_pk_bf16_f32 v85, v85, v85
    v_lshlrev_b32 v85, 16, v85
    v_cvt_u32_f32 v45, v85
    v_lshrrev_b32 v85, 23, v85
    v_subrev_u32 v85, 134, v85
    v_med3_i32 v85, v85, 0, 3
    v_lshrrev_b32 v53, 7, v45
    v_lshlrev_b32 v53, 3, v53
    v_and_or_b32 v53, v45, 7, v53
    v_lshrrev_b32 v53, v85, v53
    v_lshl_add_u32 v53, v85, 3, v53
    v_bfe_u32 v45, v45, 3, 4
    v_lshl_add_u32 v53, v53, 4, v45
    v_lshl_add_u32 v85, v53, 2, v4
    v_lshl_add_u32 v86, v3, 3, 6
    v_cvt_f32_u32 v86, v86
    v_cvt_pk_bf16_f32 v86, v86, v86
    v_lshlrev_b32 v86, 16, v86
    v_cvt_u32_f32 v46, v86
    v_lshrrev_b32 v86, 23, v86
    v_subrev_u32 v86, 134, v86
    v_med3_i32 v86, v86, 0, 3
    v_lshrrev_b32 v54, 7, v46
    v_lshlrev_b32 v54, 3, v54
    v_and_or_b32 v54, v46, 7, v54
    v_lshrrev_b32 v54, v86, v54
    v_lshl_add_u32 v54, v86, 3, v54
    v_bfe_u32 v46, v46, 3, 4
    v_lshl_add_u32 v54, v54, 4, v46
    v_lshl_add_u32 v86, v54, 2, v4
    v_lshl_add_u32 v87, v3, 3, 7
    v_cvt_f32_u32 v87, v87
    v_cvt_pk_bf16_f32 v87, v87, v87
    v_lshlrev_b32 v87, 16, v87
    v_cvt_u32_f32 v47, v87
    v_lshrrev_b32 v87, 23, v87
    v_subrev_u32 v87, 134, v87
    v_med3_i32 v87, v87, 0, 3
    v_lshrrev_b32 v55, 7, v47
    v_lshlrev_b32 v55, 3, v55
    v_and_or_b32 v55, v47, 7, v55
    v_lshrrev_b32 v55, v87, v55
    v_lshl_add_u32 v55, v87, 3, v55
    v_bfe_u32 v47, v47, 3, 4
    v_lshl_add_u32 v55, v55, 4, v47
    v_lshl_add_u32 v87, v55, 2, v4
    s_cmp_ge_u32 s3, 4
    s_cbranch_scc0 L_ssm_par
    v_subrev_u32 v3, 256, v0
    v_lshrrev_b32 v2, 5, v3
    v_mul_u32_u24 v2, 1536, v2
    v_and_b32 v3, 31, v3
    v_lshl_add_u32 v2, v3, 4, v2
    ds_write_b128 v2, v[16:19] offset:0
    s_branch L_ssm_nopar
L_ssm_par:
    s_waitcnt lgkmcnt(0)
    s_lshl_b32 s16, s5, 16
    s_and_b32 s17, s5, 0xffff0000
    s_cmp_lt_u32 s3, 2
    s_cselect_b32 s16, s16, s17
    v_mov_b32 v4, 0x3fb8aa3b
    v_mul_f32 v4, s16, v4
    v_exp_f32 v4, v4
    s_nop 0
    v_cvt_pk_bf16_f32 v4, v4, v4
    v_lshlrev_b32 v4, 16, v4
    s_waitcnt vmcnt(4)
    v_lshlrev_b32 v20, 16, v20
    v_lshlrev_b32 v21, 16, v21
    v_lshlrev_b32 v22, 16, v22
    v_lshlrev_b32 v23, 16, v23
    v_lshlrev_b32 v24, 16, v24
    v_lshlrev_b32 v25, 16, v25
    v_mul_f32 v28, v4, v20
    v_mul_f32 v28, 0x3fb8aa3b, v28
    v_mul_f32 v29, v4, v21
    v_mul_f32 v29, 0x3e22f983, v29
    v_mul_f32 v22, v4, v22
    v_mul_f32 v23, v4, v23
    v_mul_f32 v30, v24, v22
    v_fma_f32 v30, -v25, v23, v30
    v_mul_f32 v31, v24, v23
    v_fmac_f32 v31, v25, v22
    v_lshlrev_b32 v2, 4, v0
    ds_write_b128 v2, v[28:31] offset:16480
    s_nop 0
L_ssm_nopar:
    v_and_b32 v2, 15, v1
    v_lshlrev_b32 v3, 3, v2
    v_cvt_f32_u32 v12, v3
    v_lshrrev_b32 v3, 3, v2
    v_and_b32 v4, 7, v2
    v_lshl_add_u32 v3, v3, 7, v4
    v_cvt_f32_u32 v13, v3
    v_lshl_add_u32 v3, v2, 1, 16
    v_lshlrev_b32 v4, 2, v2
    v_cmp_gt_u32 vcc, 8, v2
    s_nop 1
    v_cndmask_b32 v3, v4, v3, vcc
    v_lshrrev_b32 v4, 3, v3
    v_and_b32 v3, 7, v3
    v_lshl_add_u32 v3, v4, 7, v3
    v_cvt_f32_u32 v14, v3
    v_min_u32 v3, 8, v2
    v_add_u32 v3, 8, v3
    v_lshlrev_b32 v3, 7, v3
    v_cvt_f32_u32 v15, v3
    v_lshrrev_b32 v2, 4, v1
    s_lshl_b32 s7, s3, 9
    v_lshlrev_b32 v2, 4, v2
    v_add_u32 v20, s7, v2
    v_mov_b32 v64, 0
    v_mov_b32 v65, 0
    v_mov_b32 v66, 0
    v_mov_b32 v67, 0
    v_mov_b32 v68, 0
    v_mov_b32 v69, 0
    v_mov_b32 v70, 0
    v_mov_b32 v71, 0
    v_mov_b32 v72, 0
    v_mov_b32 v73, 0
    v_mov_b32 v74, 0
    v_mov_b32 v75, 0
    s_waitcnt lgkmcnt(0)
    s_barrier
    ds_read_b128 v[96:99], v20 offset:16480
    ds_read_b128 v[100:103], v20 offset:16544
    ds_read_b128 v[104:107], v20 offset:16608
    ds_read_b128 v[108:111], v20 offset:16672
    ds_read_b128 v[112:115], v20 offset:16736
    ds_read_b128 v[116:119], v20 offset:16800
    ds_read_b128 v[120:123], v20 offset:16864
    ds_read_b128 v[124:127], v20 offset:16928
    s_waitcnt lgkmcnt(0)
    v_mul_f32 v48, v96, v12
    v_mul_f32 v49, v97, v12
    v_exp_f32 v48, v48
    v_fract_f32 v49, v49
    v_cos_f32 v50, v49
    v_sin_f32 v51, v49
    v_mul_f32 v52, v96, v13
    v_mul_f32 v53, v97, v13
    v_exp_f32 v52, v52
    v_fract_f32 v53, v53
    v_cos_f32 v54, v53
    v_sin_f32 v55, v53
    v_mul_f32 v56, v96, v14
    v_mul_f32 v57, v97, v14
    v_exp_f32 v56, v56
    v_fract_f32 v57, v57
    v_cos_f32 v58, v57
    v_sin_f32 v59, v57
    v_mul_f32 v60, v96, v15
    v_mul_f32 v61, v97, v15
    v_exp_f32 v60, v60
    v_fract_f32 v61, v61
    v_cos_f32 v62, v61
    v_sin_f32 v63, v61
    v_mul_f32 v32, v48, v50
    v_mul_f32 v33, v48, v51
    v_mul_f32 v34, v98, v54
    v_mul_f32 v35, v98, v55
    v_fma_f32 v34, -v99, v55, v34
    v_fmac_f32 v35, v99, v54
    v_mul_f32 v34, v52, v34
    v_mul_f32_e64 v35, -v52, v35
    v_mul_f32 v36, v98, v58
    v_mul_f32 v37, v98, v59
    v_fma_f32 v36, -v99, v59, v36
    v_fmac_f32 v37, v99, v58
    v_mul_f32 v36, v56, v36
    v_mul_f32_e64 v37, -v56, v37
    v_mul_f32 v38, v98, v62
    v_mul_f32 v39, v98, v63
    v_fma_f32 v38, -v99, v63, v38
    v_fmac_f32 v39, v99, v62
    v_mul_f32 v38, v60, v38
    v_mul_f32_e64 v39, -v60, v39
    v_mfma_f32_16x16x4_f32 v[64:67], v34, v32, v[64:67]
    v_mfma_f32_16x16x4_f32 v[68:71], v36, v32, v[68:71]
    v_mfma_f32_16x16x4_f32 v[72:75], v38, v32, v[72:75]
    v_mfma_f32_16x16x4_f32 v[64:67], v35, v33, v[64:67]
    v_mfma_f32_16x16x4_f32 v[68:71], v37, v33, v[68:71]
    v_mfma_f32_16x16x4_f32 v[72:75], v39, v33, v[72:75]
    v_mul_f32 v48, v100, v12
    v_mul_f32 v49, v101, v12
    v_exp_f32 v48, v48
    v_fract_f32 v49, v49
    v_cos_f32 v50, v49
    v_sin_f32 v51, v49
    v_mul_f32 v52, v100, v13
    v_mul_f32 v53, v101, v13
    v_exp_f32 v52, v52
    v_fract_f32 v53, v53
    v_cos_f32 v54, v53
    v_sin_f32 v55, v53
    v_mul_f32 v56, v100, v14
    v_mul_f32 v57, v101, v14
    v_exp_f32 v56, v56
    v_fract_f32 v57, v57
    v_cos_f32 v58, v57
    v_sin_f32 v59, v57
    v_mul_f32 v60, v100, v15
    v_mul_f32 v61, v101, v15
    v_exp_f32 v60, v60
    v_fract_f32 v61, v61
    v_cos_f32 v62, v61
    v_sin_f32 v63, v61
    v_mul_f32 v40, v48, v50
    v_mul_f32 v41, v48, v51
    v_mul_f32 v42, v102, v54
    v_mul_f32 v43, v102, v55
    v_fma_f32 v42, -v103, v55, v42
    v_fmac_f32 v43, v103, v54
    v_mul_f32 v42, v52, v42
    v_mul_f32_e64 v43, -v52, v43
    v_mul_f32 v44, v102, v58
    v_mul_f32 v45, v102, v59
    v_fma_f32 v44, -v103, v59, v44
    v_fmac_f32 v45, v103, v58
    v_mul_f32 v44, v56, v44
    v_mul_f32_e64 v45, -v56, v45
    v_mul_f32 v46, v102, v62
    v_mul_f32 v47, v102, v63
    v_fma_f32 v46, -v103, v63, v46
    v_fmac_f32 v47, v103, v62
    v_mul_f32 v46, v60, v46
    v_mul_f32_e64 v47, -v60, v47
    v_mfma_f32_16x16x4_f32 v[64:67], v42, v40, v[64:67]
    v_mfma_f32_16x16x4_f32 v[68:71], v44, v40, v[68:71]
    v_mfma_f32_16x16x4_f32 v[72:75], v46, v40, v[72:75]
    v_mfma_f32_16x16x4_f32 v[64:67], v43, v41, v[64:67]
    v_mfma_f32_16x16x4_f32 v[68:71], v45, v41, v[68:71]
    v_mfma_f32_16x16x4_f32 v[72:75], v47, v41, v[72:75]
    v_mul_f32 v48, v104, v12
    v_mul_f32 v49, v105, v12
    v_exp_f32 v48, v48
    v_fract_f32 v49, v49
    v_cos_f32 v50, v49
    v_sin_f32 v51, v49
    v_mul_f32 v52, v104, v13
    v_mul_f32 v53, v105, v13
    v_exp_f32 v52, v52
    v_fract_f32 v53, v53
    v_cos_f32 v54, v53
    v_sin_f32 v55, v53
    v_mul_f32 v56, v104, v14
    v_mul_f32 v57, v105, v14
    v_exp_f32 v56, v56
    v_fract_f32 v57, v57
    v_cos_f32 v58, v57
    v_sin_f32 v59, v57
    v_mul_f32 v60, v104, v15
    v_mul_f32 v61, v105, v15
    v_exp_f32 v60, v60
    v_fract_f32 v61, v61
    v_cos_f32 v62, v61
    v_sin_f32 v63, v61
    v_mul_f32 v32, v48, v50
    v_mul_f32 v33, v48, v51
    v_mul_f32 v34, v106, v54
    v_mul_f32 v35, v106, v55
    v_fma_f32 v34, -v107, v55, v34
    v_fmac_f32 v35, v107, v54
    v_mul_f32 v34, v52, v34
    v_mul_f32_e64 v35, -v52, v35
    v_mul_f32 v36, v106, v58
    v_mul_f32 v37, v106, v59
    v_fma_f32 v36, -v107, v59, v36
    v_fmac_f32 v37, v107, v58
    v_mul_f32 v36, v56, v36
    v_mul_f32_e64 v37, -v56, v37
    v_mul_f32 v38, v106, v62
    v_mul_f32 v39, v106, v63
    v_fma_f32 v38, -v107, v63, v38
    v_fmac_f32 v39, v107, v62
    v_mul_f32 v38, v60, v38
    v_mul_f32_e64 v39, -v60, v39
    v_mfma_f32_16x16x4_f32 v[64:67], v34, v32, v[64:67]
    v_mfma_f32_16x16x4_f32 v[68:71], v36, v32, v[68:71]
    v_mfma_f32_16x16x4_f32 v[72:75], v38, v32, v[72:75]
    v_mfma_f32_16x16x4_f32 v[64:67], v35, v33, v[64:67]
    v_mfma_f32_16x16x4_f32 v[68:71], v37, v33, v[68:71]
    v_mfma_f32_16x16x4_f32 v[72:75], v39, v33, v[72:75]
    v_mul_f32 v48, v108, v12
    v_mul_f32 v49, v109, v12
    v_exp_f32 v48, v48
    v_fract_f32 v49, v49
    v_cos_f32 v50, v49
    v_sin_f32 v51, v49
    v_mul_f32 v52, v108, v13
    v_mul_f32 v53, v109, v13
    v_exp_f32 v52, v52
    v_fract_f32 v53, v53
    v_cos_f32 v54, v53
    v_sin_f32 v55, v53
    v_mul_f32 v56, v108, v14
    v_mul_f32 v57, v109, v14
    v_exp_f32 v56, v56
    v_fract_f32 v57, v57
    v_cos_f32 v58, v57
    v_sin_f32 v59, v57
    v_mul_f32 v60, v108, v15
    v_mul_f32 v61, v109, v15
    v_exp_f32 v60, v60
    v_fract_f32 v61, v61
    v_cos_f32 v62, v61
    v_sin_f32 v63, v61
    v_mul_f32 v40, v48, v50
    v_mul_f32 v41, v48, v51
    v_mul_f32 v42, v110, v54
    v_mul_f32 v43, v110, v55
    v_fma_f32 v42, -v111, v55, v42
    v_fmac_f32 v43, v111, v54
    v_mul_f32 v42, v52, v42
    v_mul_f32_e64 v43, -v52, v43
    v_mul_f32 v44, v110, v58
    v_mul_f32 v45, v110, v59
    v_fma_f32 v44, -v111, v59, v44
    v_fmac_f32 v45, v111, v58
    v_mul_f32 v44, v56, v44
    v_mul_f32_e64 v45, -v56, v45
    v_mul_f32 v46, v110, v62
    v_mul_f32 v47, v110, v63
    v_fma_f32 v46, -v111, v63, v46
    v_fmac_f32 v47, v111, v62
    v_mul_f32 v46, v60, v46
    v_mul_f32_e64 v47, -v60, v47
    v_mfma_f32_16x16x4_f32 v[64:67], v42, v40, v[64:67]
    v_mfma_f32_16x16x4_f32 v[68:71], v44, v40, v[68:71]
    v_mfma_f32_16x16x4_f32 v[72:75], v46, v40, v[72:75]
    v_mfma_f32_16x16x4_f32 v[64:67], v43, v41, v[64:67]
    v_mfma_f32_16x16x4_f32 v[68:71], v45, v41, v[68:71]
    v_mfma_f32_16x16x4_f32 v[72:75], v47, v41, v[72:75]
    v_mul_f32 v48, v112, v12
    v_mul_f32 v49, v113, v12
    v_exp_f32 v48, v48
    v_fract_f32 v49, v49
    v_cos_f32 v50, v49
    v_sin_f32 v51, v49
    v_mul_f32 v52, v112, v13
    v_mul_f32 v53, v113, v13
    v_exp_f32 v52, v52
    v_fract_f32 v53, v53
    v_cos_f32 v54, v53
    v_sin_f32 v55, v53
    v_mul_f32 v56, v112, v14
    v_mul_f32 v57, v113, v14
    v_exp_f32 v56, v56
    v_fract_f32 v57, v57
    v_cos_f32 v58, v57
    v_sin_f32 v59, v57
    v_mul_f32 v60, v112, v15
    v_mul_f32 v61, v113, v15
    v_exp_f32 v60, v60
    v_fract_f32 v61, v61
    v_cos_f32 v62, v61
    v_sin_f32 v63, v61
    v_mul_f32 v32, v48, v50
    v_mul_f32 v33, v48, v51
    v_mul_f32 v34, v114, v54
    v_mul_f32 v35, v114, v55
    v_fma_f32 v34, -v115, v55, v34
    v_fmac_f32 v35, v115, v54
    v_mul_f32 v34, v52, v34
    v_mul_f32_e64 v35, -v52, v35
    v_mul_f32 v36, v114, v58
    v_mul_f32 v37, v114, v59
    v_fma_f32 v36, -v115, v59, v36
    v_fmac_f32 v37, v115, v58
    v_mul_f32 v36, v56, v36
    v_mul_f32_e64 v37, -v56, v37
    v_mul_f32 v38, v114, v62
    v_mul_f32 v39, v114, v63
    v_fma_f32 v38, -v115, v63, v38
    v_fmac_f32 v39, v115, v62
    v_mul_f32 v38, v60, v38
    v_mul_f32_e64 v39, -v60, v39
    v_mfma_f32_16x16x4_f32 v[64:67], v34, v32, v[64:67]
    v_mfma_f32_16x16x4_f32 v[68:71], v36, v32, v[68:71]
    v_mfma_f32_16x16x4_f32 v[72:75], v38, v32, v[72:75]
    v_mfma_f32_16x16x4_f32 v[64:67], v35, v33, v[64:67]
    v_mfma_f32_16x16x4_f32 v[68:71], v37, v33, v[68:71]
    v_mfma_f32_16x16x4_f32 v[72:75], v39, v33, v[72:75]
    v_mul_f32 v48, v116, v12
    v_mul_f32 v49, v117, v12
    v_exp_f32 v48, v48
    v_fract_f32 v49, v49
    v_cos_f32 v50, v49
    v_sin_f32 v51, v49
    v_mul_f32 v52, v116, v13
    v_mul_f32 v53, v117, v13
    v_exp_f32 v52, v52
    v_fract_f32 v53, v53
    v_cos_f32 v54, v53
    v_sin_f32 v55, v53
    v_mul_f32 v56, v116, v14
    v_mul_f32 v57, v117, v14
    v_exp_f32 v56, v56
    v_fract_f32 v57, v57
    v_cos_f32 v58, v57
    v_sin_f32 v59, v57
    v_mul_f32 v60, v116, v15
    v_mul_f32 v61, v117, v15
    v_exp_f32 v60, v60
    v_fract_f32 v61, v61
    v_cos_f32 v62, v61
    v_sin_f32 v63, v61
    v_mul_f32 v40, v48, v50
    v_mul_f32 v41, v48, v51
    v_mul_f32 v42, v118, v54
    v_mul_f32 v43, v118, v55
    v_fma_f32 v42, -v119, v55, v42
    v_fmac_f32 v43, v119, v54
    v_mul_f32 v42, v52, v42
    v_mul_f32_e64 v43, -v52, v43
    v_mul_f32 v44, v118, v58
    v_mul_f32 v45, v118, v59
    v_fma_f32 v44, -v119, v59, v44
    v_fmac_f32 v45, v119, v58
    v_mul_f32 v44, v56, v44
    v_mul_f32_e64 v45, -v56, v45
    v_mul_f32 v46, v118, v62
    v_mul_f32 v47, v118, v63
    v_fma_f32 v46, -v119, v63, v46
    v_fmac_f32 v47, v119, v62
    v_mul_f32 v46, v60, v46
    v_mul_f32_e64 v47, -v60, v47
    v_mfma_f32_16x16x4_f32 v[64:67], v42, v40, v[64:67]
    v_mfma_f32_16x16x4_f32 v[68:71], v44, v40, v[68:71]
    v_mfma_f32_16x16x4_f32 v[72:75], v46, v40, v[72:75]
    v_mfma_f32_16x16x4_f32 v[64:67], v43, v41, v[64:67]
    v_mfma_f32_16x16x4_f32 v[68:71], v45, v41, v[68:71]
    v_mfma_f32_16x16x4_f32 v[72:75], v47, v41, v[72:75]
    v_mul_f32 v48, v120, v12
    v_mul_f32 v49, v121, v12
    v_exp_f32 v48, v48
    v_fract_f32 v49, v49
    v_cos_f32 v50, v49
    v_sin_f32 v51, v49
    v_mul_f32 v52, v120, v13
    v_mul_f32 v53, v121, v13
    v_exp_f32 v52, v52
    v_fract_f32 v53, v53
    v_cos_f32 v54, v53
    v_sin_f32 v55, v53
    v_mul_f32 v56, v120, v14
    v_mul_f32 v57, v121, v14
    v_exp_f32 v56, v56
    v_fract_f32 v57, v57
    v_cos_f32 v58, v57
    v_sin_f32 v59, v57
    v_mul_f32 v60, v120, v15
    v_mul_f32 v61, v121, v15
    v_exp_f32 v60, v60
    v_fract_f32 v61, v61
    v_cos_f32 v62, v61
    v_sin_f32 v63, v61
    v_mul_f32 v32, v48, v50
    v_mul_f32 v33, v48, v51
    v_mul_f32 v34, v122, v54
    v_mul_f32 v35, v122, v55
    v_fma_f32 v34, -v123, v55, v34
    v_fmac_f32 v35, v123, v54
    v_mul_f32 v34, v52, v34
    v_mul_f32_e64 v35, -v52, v35
    v_mul_f32 v36, v122, v58
    v_mul_f32 v37, v122, v59
    v_fma_f32 v36, -v123, v59, v36
    v_fmac_f32 v37, v123, v58
    v_mul_f32 v36, v56, v36
    v_mul_f32_e64 v37, -v56, v37
    v_mul_f32 v38, v122, v62
    v_mul_f32 v39, v122, v63
    v_fma_f32 v38, -v123, v63, v38
    v_fmac_f32 v39, v123, v62
    v_mul_f32 v38, v60, v38
    v_mul_f32_e64 v39, -v60, v39
    v_mfma_f32_16x16x4_f32 v[64:67], v34, v32, v[64:67]
    v_mfma_f32_16x16x4_f32 v[68:71], v36, v32, v[68:71]
    v_mfma_f32_16x16x4_f32 v[72:75], v38, v32, v[72:75]
    v_mfma_f32_16x16x4_f32 v[64:67], v35, v33, v[64:67]
    v_mfma_f32_16x16x4_f32 v[68:71], v37, v33, v[68:71]
    v_mfma_f32_16x16x4_f32 v[72:75], v39, v33, v[72:75]
    v_mul_f32 v48, v124, v12
    v_mul_f32 v49, v125, v12
    v_exp_f32 v48, v48
    v_fract_f32 v49, v49
    v_cos_f32 v50, v49
    v_sin_f32 v51, v49
    v_mul_f32 v52, v124, v13
    v_mul_f32 v53, v125, v13
    v_exp_f32 v52, v52
    v_fract_f32 v53, v53
    v_cos_f32 v54, v53
    v_sin_f32 v55, v53
    v_mul_f32 v56, v124, v14
    v_mul_f32 v57, v125, v14
    v_exp_f32 v56, v56
    v_fract_f32 v57, v57
    v_cos_f32 v58, v57
    v_sin_f32 v59, v57
    v_mul_f32 v60, v124, v15
    v_mul_f32 v61, v125, v15
    v_exp_f32 v60, v60
    v_fract_f32 v61, v61
    v_cos_f32 v62, v61
    v_sin_f32 v63, v61
    v_mul_f32 v40, v48, v50
    v_mul_f32 v41, v48, v51
    v_mul_f32 v42, v126, v54
    v_mul_f32 v43, v126, v55
    v_fma_f32 v42, -v127, v55, v42
    v_fmac_f32 v43, v127, v54
    v_mul_f32 v42, v52, v42
    v_mul_f32_e64 v43, -v52, v43
    v_mul_f32 v44, v126, v58
    v_mul_f32 v45, v126, v59
    v_fma_f32 v44, -v127, v59, v44
    v_fmac_f32 v45, v127, v58
    v_mul_f32 v44, v56, v44
    v_mul_f32_e64 v45, -v56, v45
    v_mul_f32 v46, v126, v62
    v_mul_f32 v47, v126, v63
    v_fma_f32 v46, -v127, v63, v46
    v_fmac_f32 v47, v127, v62
    v_mul_f32 v46, v60, v46
    v_mul_f32_e64 v47, -v60, v47
    v_mfma_f32_16x16x4_f32 v[64:67], v42, v40, v[64:67]
    v_mfma_f32_16x16x4_f32 v[68:71], v44, v40, v[68:71]
    v_mfma_f32_16x16x4_f32 v[72:75], v46, v40, v[72:75]
    v_mfma_f32_16x16x4_f32 v[64:67], v43, v41, v[64:67]
    v_mfma_f32_16x16x4_f32 v[68:71], v45, v41, v[68:71]
    v_mfma_f32_16x16x4_f32 v[72:75], v47, v41, v[72:75]
    v_and_b32 v2, 15, v1
    v_lshrrev_b32 v3, 4, v1
    v_lshl_add_u32 v2, v3, 6, v2
    v_lshlrev_b32 v2, 2, v2
    s_mul_i32 s7, s3, 3072
    v_add_u32 v2, s7, v2
    s_nop 1
    ds_write_b32 v2, v64 offset:20576
    ds_write_b32 v2, v65 offset:20640
    ds_write_b32 v2, v66 offset:20704
    ds_write_b32 v2, v67 offset:20768
    ds_write_b32 v2, v68 offset:21600
    ds_write_b32 v2, v69 offset:21664
    ds_write_b32 v2, v70 offset:21728
    ds_write_b32 v2, v71 offset:21792
    ds_write_b32 v2, v72 offset:22624
    ds_write_b32 v2, v73 offset:22688
    ds_write_b32 v2, v74 offset:22752
    ds_write_b32 v2, v75 offset:22816
    v_and_b32 v3, 255, v0
    v_lshrrev_b32 v2, 8, v0
    s_waitcnt vmcnt(0)
    v_sub_u32 v4, 2047, v0
    v_lshlrev_b32 v4, 1, v4
    v_add_u32 v4, 9216, v4
    ds_write_b16 v4, v8 offset:3072
    ds_write_b16_d16_hi v4, v8 offset:36352
    ds_write_b16 v4, v9 offset:2048
    ds_write_b16_d16_hi v4, v9 offset:35328
    ds_write_b16 v4, v10 offset:1024
    ds_write_b16_d16_hi v4, v10 offset:34304
    ds_write_b16 v4, v11 offset:0
    ds_write_b16_d16_hi v4, v11 offset:33280
    v_mul_u32_u24 v6, 33280, v2
    v_lshl_add_u32 v6, v3, 4, v6
    v_add_u32 v6, 12288, v6
    v_cmp_gt_u32 vcc, 4, v3
    s_nop 1
    s_and_saveexec_b64 s[16:17], vcc
    s_nop 0
    s_cbranch_execz L_ssm_noext0
    ds_write_b128 v6, v[16:19] offset:4096
L_ssm_noext0:
    s_mov_b64 exec, s[16:17]
    s_waitcnt lgkmcnt(0)
    s_barrier
    ds_read_b32 v32, v80 offset:20576
    ds_read_b32 v33, v80 offset:23648
    ds_read_b32 v34, v80 offset:26720
    ds_read_b32 v35, v80 offset:29792
    ds_read_b32 v36, v81 offset:20576
    ds_read_b32 v37, v81 offset:23648
    ds_read_b32 v38, v81 offset:26720
    ds_read_b32 v39, v81 offset:29792
    ds_read_b32 v40, v82 offset:20576
    ds_read_b32 v41, v82 offset:23648
    ds_read_b32 v42, v82 offset:26720
    ds_read_b32 v43, v82 offset:29792
    s_waitcnt lgkmcnt(4)
    ds_read_b32 v44, v83 offset:20576
    ds_read_b32 v45, v83 offset:23648
    ds_read_b32 v46, v83 offset:26720
    ds_read_b32 v47, v83 offset:29792
    ds_read_b32 v48, v84 offset:20576
    ds_read_b32 v49, v84 offset:23648
    ds_read_b32 v50, v84 offset:26720
    ds_read_b32 v51, v84 offset:29792
    ds_read_b32 v52, v85 offset:20576
    ds_read_b32 v53, v85 offset:23648
    ds_read_b32 v54, v85 offset:26720
    ds_read_b32 v55, v85 offset:29792
    s_waitcnt lgkmcnt(4)
    ds_read_b32 v56, v86 offset:20576
    ds_read_b32 v57, v86 offset:23648
    ds_read_b32 v58, v86 offset:26720
    ds_read_b32 v59, v86 offset:29792
    ds_read_b32 v60, v87 offset:20576
    ds_read_b32 v61, v87 offset:23648
    ds_read_b32 v62, v87 offset:26720
    ds_read_b32 v63, v87 offset:29792
    s_waitcnt lgkmcnt(0)
    v_add_f32 v32, v32, v33
    v_add_f32 v34, v34, v35
    v_add_f32 v32, v32, v34
    v_add_f32 v36, v36, v37
    v_add_f32 v38, v38, v39
    v_add_f32 v36, v36, v38
    v_add_f32 v40, v40, v41
    v_add_f32 v42, v42, v43
    v_add_f32 v40, v40, v42
    v_add_f32 v44, v44, v45
    v_add_f32 v46, v46, v47
    v_add_f32 v44, v44, v46
    v_add_f32 v48, v48, v49
    v_add_f32 v50, v50, v51
    v_add_f32 v48, v48, v50
    v_add_f32 v52, v52, v53
    v_add_f32 v54, v54, v55
    v_add_f32 v52, v52, v54
    v_add_f32 v56, v56, v57
    v_add_f32 v58, v58, v59
    v_add_f32 v56, v56, v58
    v_add_f32 v60, v60, v61
    v_add_f32 v62, v62, v63
    v_add_f32 v60, v60, v62
    v_cvt_pk_bf16_f32 v64, v32, v36
    v_cvt_pk_bf16_f32 v65, v40, v44
    v_cvt_pk_bf16_f32 v66, v48, v52
    v_cvt_pk_bf16_f32 v67, v56, v60
    v_and_b32 v4, 3, v3
    v_mul_u32_u24 v4, 1536, v4
    v_mul_u32_u24 v5, 6144, v2
    v_add_u32 v4, v4, v5
    v_lshrrev_b32 v5, 2, v3
    v_lshl_add_u32 v4, v5, 4, v4
    ds_write_b128 v4, v[64:67] offset:512
    s_waitcnt lgkmcnt(0)
    s_barrier
    v_mov_b32 v5, v6
    v_cmp_gt_u32 vcc, 4, v3
    s_nop 1
    s_and_saveexec_b64 s[16:17], vcc
    s_nop 0
    s_cbranch_execz L_ssm_noext
    ds_write_b128 v5, v[16:19] offset:8256
    ds_write_b128 v5, v[16:19] offset:12416
    ds_write_b128 v5, v[16:19] offset:16576
    ds_write_b128 v5, v[16:19] offset:20736
    ds_write_b128 v5, v[16:19] offset:24896
    ds_write_b128 v5, v[16:19] offset:29056
    ds_write_b128 v5, v[16:19] offset:33216
L_ssm_noext:
    s_mov_b64 exec, s[16:17]
    ds_read_b128 v[32:35], v5
    ds_read_b128 v[36:39], v5 offset:16
    s_waitcnt lgkmcnt(0)
    v_alignbyte_b32 v44, v33, v32, 2
    v_alignbyte_b32 v45, v34, v33, 2
    v_alignbyte_b32 v46, v35, v34, 2
    v_alignbyte_b32 v47, v36, v35, 2
    ds_write_b128 v5, v[44:47] offset:4160
    v_mov_b32 v48, v33
    v_mov_b32 v49, v34
    v_mov_b32 v50, v35
    v_mov_b32 v51, v36
    ds_write_b128 v5, v[48:51] offset:8320
    v_alignbyte_b32 v52, v34, v33, 2
    v_alignbyte_b32 v53, v35, v34, 2
    v_alignbyte_b32 v54, v36, v35, 2
    v_alignbyte_b32 v55, v37, v36, 2
    ds_write_b128 v5, v[52:55] offset:12480
    v_mov_b32 v40, v34
    v_mov_b32 v41, v35
    v_mov_b32 v42, v36
    v_mov_b32 v43, v37
    ds_write_b128 v5, v[40:43] offset:16640
    v_alignbyte_b32 v44, v35, v34, 2
    v_alignbyte_b32 v45, v36, v35, 2
    v_alignbyte_b32 v46, v37, v36, 2
    v_alignbyte_b32 v47, v38, v37, 2
    ds_write_b128 v5, v[44:47] offset:20800
    v_mov_b32 v48, v35
    v_mov_b32 v49, v36
    v_mov_b32 v50, v37
    v_mov_b32 v51, v38
    ds_write_b128 v5, v[48:51] offset:24960
    v_alignbyte_b32 v52, v36, v35, 2
    v_alignbyte_b32 v53, v37, v36, 2
    v_alignbyte_b32 v54, v38, v37, 2
    v_alignbyte_b32 v55, v39, v38, 2
    ds_write_b128 v5, v[52:55] offset:29120
    v_and_b32 v2, 31, v1
    v_lshrrev_b32 v3, 5, v1
    v_sub_u32 v4, 7, v2
    v_and_b32 v4, 7, v4
    v_mul_u32_u24 v12, 4160, v4
    v_lshrrev_b32 v4, 3, v2
    v_sub_u32 v4, v3, v4
    v_lshl_add_u32 v12, v4, 4, v12
    s_lshr_b32 s7, s3, 2
    s_and_b32 s17, s3, 3
    s_mul_i32 s16, s7, 33280
    s_lshl_b32 s18, s17, 6
    s_sub_u32 s16, s16, s18
    s_add_u32 s16, s16, 12528
    v_add_u32 v12, s16, v12
    v_mul_u32_u24 v13, 1536, v3
    v_lshl_add_u32 v13, v2, 4, v13
    s_mul_i32 s16, s7, 6144
    s_lshl_b32 s18, s17, 4
    s_sub_u32 s16, s16, s18
    s_add_u32 s16, s16, 64
    v_add_u32 v13, s16, v13
    v_subrev_u32 v14, 512, v13
    s_waitcnt lgkmcnt(0)
    s_barrier
    ds_read_b128 v[72:75], v12 offset:3840
    ds_read_b128 v[76:79], v13 offset:960
    ds_read_b128 v[80:83], v14 offset:960
    ds_read_b128 v[84:87], v12 offset:3872
    ds_read_b128 v[88:91], v13 offset:4032
    ds_read_b128 v[92:95], v14 offset:4032
    ds_read_b128 v[96:99], v12 offset:3584
    ds_read_b128 v[100:103], v13 offset:896
    s_waitcnt lgkmcnt(6)
    v_mfma_f32_32x32x16_bf16 v[48:63], v[72:75], v[76:79], 0
    ds_read_b128 v[104:107], v14 offset:896
    s_waitcnt lgkmcnt(6)
    v_mfma_f32_32x32x16_bf16 v[32:47], v[72:75], v[80:83], 0
    ds_read_b128 v[108:111], v12 offset:3616
    ds_read_b128 v[72:75], v13 offset:3968
    s_waitcnt lgkmcnt(6)
    v_mfma_f32_32x32x16_bf16 v[48:63], v[84:87], v[88:91], v[48:63]
    ds_read_b128 v[76:79], v14 offset:3968
    s_waitcnt lgkmcnt(6)
    v_mfma_f32_32x32x16_bf16 v[32:47], v[84:87], v[92:95], v[32:47]
    ds_read_b128 v[80:83], v12 offset:3328
    ds_read_b128 v[84:87], v13 offset:832
    s_waitcnt lgkmcnt(6)
    v_mfma_f32_32x32x16_bf16 v[48:63], v[96:99], v[100:103], v[48:63]
    ds_read_b128 v[88:91], v14 offset:832
    s_waitcnt lgkmcnt(6)
    v_mfma_f32_32x32x16_bf16 v[32:47], v[96:99], v[104:107], v[32:47]
    ds_read_b128 v[92:95], v12 offset:3360
    ds_read_b128 v[96:99], v13 offset:3904
    s_waitcnt lgkmcnt(6)
    v_mfma_f32_32x32x16_bf16 v[48:63], v[108:111], v[72:75], v[48:63]
    ds_read_b128 v[100:103], v14 offset:3904
    s_waitcnt lgkmcnt(6)
    v_mfma_f32_32x32x16_bf16 v[32:47], v[108:111], v[76:79], v[32:47]
    ds_read_b128 v[104:107], v12 offset:3072
    ds_read_b128 v[108:111], v13 offset:768
    s_waitcnt lgkmcnt(6)
    v_mfma_f32_32x32x16_bf16 v[48:63], v[80:83], v[84:87], v[48:63]
    ds_read_b128 v[72:75], v14 offset:768
    s_waitcnt lgkmcnt(6)
    v_mfma_f32_32x32x16_bf16 v[32:47], v[80:83], v[88:91], v[32:47]
    ds_read_b128 v[76:79], v12 offset:3104
    ds_read_b128 v[80:83], v13 offset:3840
    s_waitcnt lgkmcnt(6)
    v_mfma_f32_32x32x16_bf16 v[48:63], v[92:95], v[96:99], v[48:63]
    ds_read_b128 v[84:87], v14 offset:3840
    s_waitcnt lgkmcnt(6)
    v_mfma_f32_32x32x16_bf16 v[32:47], v[92:95], v[100:103], v[32:47]
    ds_read_b128 v[88:91], v12 offset:2816
    ds_read_b128 v[92:95], v13 offset:704
    s_waitcnt lgkmcnt(6)
    v_mfma_f32_32x32x16_bf16 v[48:63], v[104:107], v[108:111], v[48:63]
    ds_read_b128 v[96:99], v14 offset:704
    s_waitcnt lgkmcnt(6)
    v_mfma_f32_32x32x16_bf16 v[32:47], v[104:107], v[72:75], v[32:47]
    ds_read_b128 v[100:103], v12 offset:2848
    ds_read_b128 v[104:107], v13 offset:3776
    s_waitcnt lgkmcnt(6)
    v_mfma_f32_32x32x16_bf16 v[48:63], v[76:79], v[80:83], v[48:63]
    ds_read_b128 v[108:111], v14 offset:3776
    s_waitcnt lgkmcnt(6)
    v_mfma_f32_32x32x16_bf16 v[32:47], v[76:79], v[84:87], v[32:47]
    ds_read_b128 v[72:75], v12 offset:2560
    ds_read_b128 v[76:79], v13 offset:640
    s_waitcnt lgkmcnt(6)
    v_mfma_f32_32x32x16_bf16 v[48:63], v[88:91], v[92:95], v[48:63]
    ds_read_b128 v[80:83], v14 offset:640
    s_waitcnt lgkmcnt(6)
    v_mfma_f32_32x32x16_bf16 v[32:47], v[88:91], v[96:99], v[32:47]
    ds_read_b128 v[84:87], v12 offset:2592
    ds_read_b128 v[88:91], v13 offset:3712
    s_waitcnt lgkmcnt(6)
    v_mfma_f32_32x32x16_bf16 v[48:63], v[100:103], v[104:107], v[48:63]
    ds_read_b128 v[92:95], v14 offset:3712
    s_waitcnt lgkmcnt(6)
    v_mfma_f32_32x32x16_bf16 v[32:47], v[100:103], v[108:111], v[32:47]
    ds_read_b128 v[96:99], v12 offset:2304
    ds_read_b128 v[100:103], v13 offset:576
    s_waitcnt lgkmcnt(6)
    v_mfma_f32_32x32x16_bf16 v[48:63], v[72:75], v[76:79], v[48:63]
    ds_read_b128 v[104:107], v14 offset:576
    s_waitcnt lgkmcnt(6)
    v_mfma_f32_32x32x16_bf16 v[32:47], v[72:75], v[80:83], v[32:47]
    ds_read_b128 v[108:111], v12 offset:2336
    ds_read_b128 v[72:75], v13 offset:3648
    s_waitcnt lgkmcnt(6)
    v_mfma_f32_32x32x16_bf16 v[48:63], v[84:87], v[88:91], v[48:63]
    ds_read_b128 v[76:79], v14 offset:3648
    s_waitcnt lgkmcnt(6)
    v_mfma_f32_32x32x16_bf16 v[32:47], v[84:87], v[92:95], v[32:47]
    ds_read_b128 v[80:83], v12 offset:2048
    ds_read_b128 v[84:87], v13 offset:512
    s_waitcnt lgkmcnt(6)
    v_mfma_f32_32x32x16_bf16 v[48:63], v[96:99], v[100:103], v[48:63]
    ds_read_b128 v[88:91], v14 offset:512
    s_waitcnt lgkmcnt(6)
    v_mfma_f32_32x32x16_bf16 v[32:47], v[96:99], v[104:107], v[32:47]
    ds_read_b128 v[92:95], v12 offset:2080
    ds_read_b128 v[96:99], v13 offset:3584
    s_waitcnt lgkmcnt(6)
    v_mfma_f32_32x32x16_bf16 v[48:63], v[108:111], v[72:75], v[48:63]
    ds_read_b128 v[100:103], v14 offset:3584
    s_waitcnt lgkmcnt(6)
    v_mfma_f32_32x32x16_bf16 v[32:47], v[108:111], v[76:79], v[32:47]
    ds_read_b128 v[104:107], v12 offset:1792
    ds_read_b128 v[108:111], v13 offset:448
    s_waitcnt lgkmcnt(6)
    v_mfma_f32_32x32x16_bf16 v[48:63], v[80:83], v[84:87], v[48:63]
    ds_read_b128 v[72:75], v12 offset:1824
    s_waitcnt lgkmcnt(6)
    v_mfma_f32_32x32x16_bf16 v[32:47], v[80:83], v[88:91], v[32:47]
    ds_read_b128 v[76:79], v13 offset:3520
    ds_read_b128 v[80:83], v12 offset:1536
    s_waitcnt lgkmcnt(6)
    v_mfma_f32_32x32x16_bf16 v[48:63], v[92:95], v[96:99], v[48:63]
    ds_read_b128 v[84:87], v13 offset:384
    s_waitcnt lgkmcnt(6)
    v_mfma_f32_32x32x16_bf16 v[32:47], v[92:95], v[100:103], v[32:47]
    ds_read_b128 v[88:91], v12 offset:1568
    ds_read_b128 v[92:95], v13 offset:3456
    s_waitcnt lgkmcnt(6)
    v_mfma_f32_32x32x16_bf16 v[48:63], v[104:107], v[108:111], v[48:63]
    ds_read_b128 v[96:99], v12 offset:1280
    ds_read_b128 v[100:103], v13 offset:320
    s_waitcnt lgkmcnt(6)
    v_mfma_f32_32x32x16_bf16 v[48:63], v[72:75], v[76:79], v[48:63]
    ds_read_b128 v[104:107], v12 offset:1312
    ds_read_b128 v[108:111], v13 offset:3392
    s_waitcnt lgkmcnt(6)
    v_mfma_f32_32x32x16_bf16 v[48:63], v[80:83], v[84:87], v[48:63]
    ds_read_b128 v[72:75], v12 offset:1024
    ds_read_b128 v[76:79], v13 offset:256
    s_waitcnt lgkmcnt(6)
    v_mfma_f32_32x32x16_bf16 v[48:63], v[88:91], v[92:95], v[48:63]
    ds_read_b128 v[80:83], v12 offset:1056
    ds_read_b128 v[84:87], v13 offset:3328
    s_waitcnt lgkmcnt(6)
    v_mfma_f32_32x32x16_bf16 v[48:63], v[96:99], v[100:103], v[48:63]
    ds_read_b128 v[88:91], v12 offset:768
    ds_read_b128 v[92:95], v13 offset:192
    s_waitcnt lgkmcnt(6)
    v_mfma_f32_32x32x16_bf16 v[48:63], v[104:107], v[108:111], v[48:63]
    ds_read_b128 v[96:99], v12 offset:800
    ds_read_b128 v[100:103], v13 offset:3264
    s_waitcnt lgkmcnt(6)
    v_mfma_f32_32x32x16_bf16 v[48:63], v[72:75], v[76:79], v[48:63]
    ds_read_b128 v[104:107], v12 offset:512
    ds_read_b128 v[108:111], v13 offset:128
    s_waitcnt lgkmcnt(6)
    v_mfma_f32_32x32x16_bf16 v[48:63], v[80:83], v[84:87], v[48:63]
    ds_read_b128 v[72:75], v12 offset:544
    ds_read_b128 v[76:79], v13 offset:3200
    s_waitcnt lgkmcnt(6)
    v_mfma_f32_32x32x16_bf16 v[48:63], v[88:91], v[92:95], v[48:63]
    ds_read_b128 v[80:83], v12 offset:256
    ds_read_b128 v[84:87], v13 offset:64
    s_waitcnt lgkmcnt(6)
    v_mfma_f32_32x32x16_bf16 v[48:63], v[96:99], v[100:103], v[48:63]
    ds_read_b128 v[88:91], v12 offset:288
    ds_read_b128 v[92:95], v13 offset:3136
    s_waitcnt lgkmcnt(6)
    v_mfma_f32_32x32x16_bf16 v[48:63], v[104:107], v[108:111], v[48:63]
    ds_read_b128 v[96:99], v12 offset:0
    ds_read_b128 v[100:103], v13 offset:0
    s_waitcnt lgkmcnt(6)
    v_mfma_f32_32x32x16_bf16 v[48:63], v[72:75], v[76:79], v[48:63]
    ds_read_b128 v[104:107], v12 offset:32
    ds_read_b128 v[108:111], v13 offset:3072
    s_waitcnt lgkmcnt(6)
    v_mfma_f32_32x32x16_bf16 v[48:63], v[80:83], v[84:87], v[48:63]
    s_waitcnt lgkmcnt(4)
    v_mfma_f32_32x32x16_bf16 v[48:63], v[88:91], v[92:95], v[48:63]
    s_waitcnt lgkmcnt(2)
    v_mfma_f32_32x32x16_bf16 v[48:63], v[96:99], v[100:103], v[48:63]
    s_waitcnt lgkmcnt(0)
    v_mfma_f32_32x32x16_bf16 v[48:63], v[104:107], v[108:111], v[48:63]
    s_barrier
    v_mul_u32_u24 v4, 144, v2
    v_lshl_add_u32 v4, v3, 4, v4
    s_mul_i32 s16, s3, 9216
    v_add_u32 v4, s16, v4
    ds_write_b128 v4, v[32:35] offset:0
    ds_write_b128 v4, v[36:39] offset:32
    ds_write_b128 v4, v[40:43] offset:64
    ds_write_b128 v4, v[44:47] offset:96
    s_nop 2
    ds_write_b128 v4, v[48:51] offset:4608
    ds_write_b128 v4, v[52:55] offset:4640
    ds_write_b128 v4, v[56:59] offset:4672
    ds_write_b128 v4, v[60:63] offset:4704
    s_waitcnt lgkmcnt(0)
    s_barrier
    v_lshrrev_b32 v2, 5, v0
    v_mul_u32_u24 v2, 144, v2
    v_and_b32 v3, 31, v0
    v_lshl_add_u32 v2, v3, 2, v2
    v_add_u32 v3, 36864, v2
    ds_read_b32 v32, v2 offset:0
    ds_read_b32 v33, v2 offset:9216
    ds_read_b32 v34, v2 offset:18432
    ds_read_b32 v35, v2 offset:27648
    ds_read_b32 v36, v3 offset:0
    ds_read_b32 v37, v3 offset:9216
    ds_read_b32 v38, v3 offset:18432
    ds_read_b32 v39, v3 offset:27648
    s_waitcnt lgkmcnt(4)
    ds_read_b32 v40, v2 offset:2304
    ds_read_b32 v41, v2 offset:11520
    ds_read_b32 v42, v2 offset:20736
    ds_read_b32 v43, v2 offset:29952
    ds_read_b32 v44, v3 offset:2304
    ds_read_b32 v45, v3 offset:11520
    ds_read_b32 v46, v3 offset:20736
    ds_read_b32 v47, v3 offset:29952
    s_waitcnt lgkmcnt(4)
    ds_read_b32 v48, v2 offset:4608
    ds_read_b32 v49, v2 offset:13824
    ds_read_b32 v50, v2 offset:23040
    ds_read_b32 v51, v2 offset:32256
    ds_read_b32 v52, v3 offset:4608
    ds_read_b32 v53, v3 offset:13824
    ds_read_b32 v54, v3 offset:23040
    ds_read_b32 v55, v3 offset:32256
    s_waitcnt lgkmcnt(4)
    ds_read_b32 v56, v2 offset:6912
    ds_read_b32 v57, v2 offset:16128
    ds_read_b32 v58, v2 offset:25344
    ds_read_b32 v59, v2 offset:34560
    ds_read_b32 v60, v3 offset:6912
    ds_read_b32 v61, v3 offset:16128
    ds_read_b32 v62, v3 offset:25344
    ds_read_b32 v63, v3 offset:34560
    s_waitcnt lgkmcnt(4)
    s_lshl_b32 s16, s6, 16
    s_and_b32 s17, s6, 0xffff0000
    v_lshlrev_b32 v2, 11, v0
    s_waitcnt lgkmcnt(0)
    v_add_f32 v32, v32, v33
    v_add_f32 v34, v34, v35
    v_add_f32 v32, v32, v34
    v_add_f32 v36, v36, v37
    v_add_f32 v38, v38, v39
    v_add_f32 v36, v36, v38
    v_cvt_pk_bf16_f32 v32, v32, v36
    v_lshlrev_b32 v64, 16, v8
    v_and_b32 v65, 0xffff0000, v8
    v_mul_f32 v64, s16, v64
    v_mul_f32 v65, s17, v65
    v_cvt_pk_bf16_f32 v64, v64, v65
    v_lshlrev_b32 v66, 16, v32
    v_and_b32 v67, 0xffff0000, v32
    v_lshlrev_b32 v65, 16, v64
    v_and_b32 v64, 0xffff0000, v64
    v_add_f32 v66, v66, v65
    v_add_f32 v67, v67, v64
    v_cvt_pk_bf16_f32 v68, v66, v67
    s_add_u32 s18, s4, 0x400
    buffer_store_dword v68, v2, s[12:15], s18 offen
    v_add_f32 v40, v40, v41
    v_add_f32 v42, v42, v43
    v_add_f32 v40, v40, v42
    v_add_f32 v44, v44, v45
    v_add_f32 v46, v46, v47
    v_add_f32 v44, v44, v46
    v_cvt_pk_bf16_f32 v40, v40, v44
    v_lshlrev_b32 v64, 16, v9
    v_and_b32 v65, 0xffff0000, v9
    v_mul_f32 v64, s16, v64
    v_mul_f32 v65, s17, v65
    v_cvt_pk_bf16_f32 v64, v64, v65
    v_lshlrev_b32 v66, 16, v40
    v_and_b32 v67, 0xffff0000, v40
    v_lshlrev_b32 v65, 16, v64
    v_and_b32 v64, 0xffff0000, v64
    v_add_f32 v66, v66, v65
    v_add_f32 v67, v67, v64
    v_cvt_pk_bf16_f32 v69, v66, v67
    s_add_u32 s18, s4, 0x100400
    buffer_store_dword v69, v2, s[12:15], s18 offen
    v_add_f32 v48, v48, v49
    v_add_f32 v50, v50, v51
    v_add_f32 v48, v48, v50
    v_add_f32 v52, v52, v53
    v_add_f32 v54, v54, v55
    v_add_f32 v52, v52, v54
    v_cvt_pk_bf16_f32 v48, v48, v52
    v_lshlrev_b32 v64, 16, v10
    v_and_b32 v65, 0xffff0000, v10
    v_mul_f32 v64, s16, v64
    v_mul_f32 v65, s17, v65
    v_cvt_pk_bf16_f32 v64, v64, v65
    v_lshlrev_b32 v66, 16, v48
    v_and_b32 v67, 0xffff0000, v48
    v_lshlrev_b32 v65, 16, v64
    v_and_b32 v64, 0xffff0000, v64
    v_add_f32 v66, v66, v65
    v_add_f32 v67, v67, v64
    v_cvt_pk_bf16_f32 v70, v66, v67
    s_add_u32 s18, s4, 0x200400
    buffer_store_dword v70, v2, s[12:15], s18 offen
    v_add_f32 v56, v56, v57
    v_add_f32 v58, v58, v59
    v_add_f32 v56, v56, v58
    v_add_f32 v60, v60, v61
    v_add_f32 v62, v62, v63
    v_add_f32 v60, v60, v62
    v_cvt_pk_bf16_f32 v56, v56, v60
    v_lshlrev_b32 v64, 16, v11
    v_and_b32 v65, 0xffff0000, v11
    v_mul_f32 v64, s16, v64
    v_mul_f32 v65, s17, v65
    v_cvt_pk_bf16_f32 v64, v64, v65
    v_lshlrev_b32 v66, 16, v56
    v_and_b32 v67, 0xffff0000, v56
    v_lshlrev_b32 v65, 16, v64
    v_and_b32 v64, 0xffff0000, v64
    v_add_f32 v66, v66, v65
    v_add_f32 v67, v67, v64
    v_cvt_pk_bf16_f32 v71, v66, v67
    s_add_u32 s18, s4, 0x300400
    buffer_store_dword v71, v2, s[12:15], s18 offen
    s_endpgm
L_k34_second:
    s_load_dwordx2 s[42:43], s[0:1], 136
    s_load_dwordx2 s[44:45], s[0:1], 120
    v_lshrrev_b32 v116, 6, v0
    s_nop 0
    v_readfirstlane_b32 s3, v116
    v_and_b32 v116, 63, v0
    s_and_b32 s22, s60, 7
    s_lshr_b32 s23, s60, 3
    s_lshr_b32 s4, s22, 1
    s_lshl_b32 s4, s4, 3
    s_and_b32 s24, s23, 7
    s_add_u32 s4, s4, s24
    s_and_b32 s5, s22, 1
    s_lshl_b32 s5, s5, 2
    s_lshr_b32 s24, s23, 3
    s_add_u32 s5, s5, s24
    v_lshlrev_b32 v112, 4, v116
    v_and_b32 v117, 31, v116
    v_lshlrev_b32 v117, 11, v117
    v_lshrrev_b32 v118, 5, v116
    v_lshl_add_u32 v114, v118, 4, v117
    s_waitcnt lgkmcnt(0)
    s_mov_b32 s12, s42
    s_and_b32 s13, s43, 0xffff
    s_mov_b32 s14, 0x4800000
    s_mov_b32 s15, 0x20000
    s_mov_b32 s16, s44
    s_and_b32 s17, s45, 0xffff
    s_mov_b32 s18, 0x400000
    s_mov_b32 s19, 0x20000
    s_lshl_b32 s21, s3, 10
    s_lshl_b32 s6, s4, 19
    s_add_u32 s6, s6, s21
    s_add_u32 s6, s6, 0x3000000
    s_add_u32 s7, s6, 0x40000
    s_lshl_b32 s8, s5, 19
    s_add_u32 s8, s8, s21
    s_add_u32 s8, s8, 0x4000000
    s_add_u32 s9, s8, 0x40000
    buffer_load_dwordx4 v[64:67], v112, s[12:15], s6 offen
    buffer_load_dwordx4 v[68:71], v112, s[12:15], s7 offen
    buffer_load_dwordx4 v[72:75], v112, s[12:15], s8 offen
    buffer_load_dwordx4 v[76:79], v112, s[12:15], s9 offen
    s_add_u32 s6, s6, 8192
    buffer_load_dwordx4 v[80:83], v112, s[12:15], s6 offen
    s_add_u32 s7, s7, 8192
    buffer_load_dwordx4 v[84:87], v112, s[12:15], s7 offen
    s_add_u32 s8, s8, 8192
    buffer_load_dwordx4 v[88:91], v112, s[12:15], s8 offen
    s_add_u32 s9, s9, 8192
    buffer_load_dwordx4 v[92:95], v112, s[12:15], s9 offen
    s_add_u32 s6, s6, 8192
    buffer_load_dwordx4 v[96:99], v112, s[12:15], s6 offen
    s_add_u32 s7, s7, 8192
    buffer_load_dwordx4 v[100:103], v112, s[12:15], s7 offen
    s_add_u32 s8, s8, 8192
    buffer_load_dwordx4 v[104:107], v112, s[12:15], s8 offen
    s_add_u32 s9, s9, 8192
    buffer_load_dwordx4 v[108:111], v112, s[12:15], s9 offen
    s_waitcnt vmcnt(8)
    v_mfma_f32_32x32x16_bf16 v[0:15], v[72:75], v[64:67], 0
    v_mfma_f32_32x32x16_bf16 v[16:31], v[72:75], v[68:71], 0
    v_mfma_f32_32x32x16_bf16 v[32:47], v[76:79], v[64:67], 0
    v_mfma_f32_32x32x16_bf16 v[48:63], v[76:79], v[68:71], 0
    s_add_u32 s6, s6, 8192
    buffer_load_dwordx4 v[64:67], v112, s[12:15], s6 offen
    s_add_u32 s7, s7, 8192
    buffer_load_dwordx4 v[68:71], v112, s[12:15], s7 offen
    s_add_u32 s8, s8, 8192
    buffer_load_dwordx4 v[72:75], v112, s[12:15], s8 offen
    s_add_u32 s9, s9, 8192
    buffer_load_dwordx4 v[76:79], v112, s[12:15], s9 offen
    s_waitcnt vmcnt(8)
    v_mfma_f32_32x32x16_bf16 v[0:15], v[88:91], v[80:83], v[0:15]
    v_mfma_f32_32x32x16_bf16 v[16:31], v[88:91], v[84:87], v[16:31]
    v_mfma_f32_32x32x16_bf16 v[32:47], v[92:95], v[80:83], v[32:47]
    v_mfma_f32_32x32x16_bf16 v[48:63], v[92:95], v[84:87], v[48:63]
    s_add_u32 s6, s6, 8192
    buffer_load_dwordx4 v[80:83], v112, s[12:15], s6 offen
    s_add_u32 s7, s7, 8192
    buffer_load_dwordx4 v[84:87], v112, s[12:15], s7 offen
    s_add_u32 s8, s8, 8192
    buffer_load_dwordx4 v[88:91], v112, s[12:15], s8 offen
    s_add_u32 s9, s9, 8192
    buffer_load_dwordx4 v[92:95], v112, s[12:15], s9 offen
    s_waitcnt vmcnt(8)
    v_mfma_f32_32x32x16_bf16 v[0:15], v[104:107], v[96:99], v[0:15]
    v_mfma_f32_32x32x16_bf16 v[16:31], v[104:107], v[100:103], v[16:31]
    v_mfma_f32_32x32x16_bf16 v[32:47], v[108:111], v[96:99], v[32:47]
    v_mfma_f32_32x32x16_bf16 v[48:63], v[108:111], v[100:103], v[48:63]
    s_add_u32 s6, s6, 8192
    buffer_load_dwordx4 v[96:99], v112, s[12:15], s6 offen
    s_add_u32 s7, s7, 8192
    buffer_load_dwordx4 v[100:103], v112, s[12:15], s7 offen
    s_add_u32 s8, s8, 8192
    buffer_load_dwordx4 v[104:107], v112, s[12:15], s8 offen
    s_add_u32 s9, s9, 8192
    buffer_load_dwordx4 v[108:111], v112, s[12:15], s9 offen
    s_waitcnt vmcnt(8)
    v_mfma_f32_32x32x16_bf16 v[0:15], v[72:75], v[64:67], v[0:15]
    v_mfma_f32_32x32x16_bf16 v[16:31], v[72:75], v[68:71], v[16:31]
    v_mfma_f32_32x32x16_bf16 v[32:47], v[76:79], v[64:67], v[32:47]
    v_mfma_f32_32x32x16_bf16 v[48:63], v[76:79], v[68:71], v[48:63]
    s_add_u32 s6, s6, 8192
    buffer_load_dwordx4 v[64:67], v112, s[12:15], s6 offen
    s_add_u32 s7, s7, 8192
    buffer_load_dwordx4 v[68:71], v112, s[12:15], s7 offen
    s_add_u32 s8, s8, 8192
    buffer_load_dwordx4 v[72:75], v112, s[12:15], s8 offen
    s_add_u32 s9, s9, 8192
    buffer_load_dwordx4 v[76:79], v112, s[12:15], s9 offen
    s_waitcnt vmcnt(8)
    v_mfma_f32_32x32x16_bf16 v[0:15], v[88:91], v[80:83], v[0:15]
    v_mfma_f32_32x32x16_bf16 v[16:31], v[88:91], v[84:87], v[16:31]
    v_mfma_f32_32x32x16_bf16 v[32:47], v[92:95], v[80:83], v[32:47]
    v_mfma_f32_32x32x16_bf16 v[48:63], v[92:95], v[84:87], v[48:63]
    s_add_u32 s6, s6, 8192
    buffer_load_dwordx4 v[80:83], v112, s[12:15], s6 offen
    s_add_u32 s7, s7, 8192
    buffer_load_dwordx4 v[84:87], v112, s[12:15], s7 offen
    s_add_u32 s8, s8, 8192
    buffer_load_dwordx4 v[88:91], v112, s[12:15], s8 offen
    s_add_u32 s9, s9, 8192
    buffer_load_dwordx4 v[92:95], v112, s[12:15], s9 offen
    s_waitcnt vmcnt(8)
    v_mfma_f32_32x32x16_bf16 v[0:15], v[104:107], v[96:99], v[0:15]
    v_mfma_f32_32x32x16_bf16 v[16:31], v[104:107], v[100:103], v[16:31]
    v_mfma_f32_32x32x16_bf16 v[32:47], v[108:111], v[96:99], v[32:47]
    v_mfma_f32_32x32x16_bf16 v[48:63], v[108:111], v[100:103], v[48:63]
    s_add_u32 s6, s6, 8192
    buffer_load_dwordx4 v[96:99], v112, s[12:15], s6 offen
    s_add_u32 s7, s7, 8192
    buffer_load_dwordx4 v[100:103], v112, s[12:15], s7 offen
    s_add_u32 s8, s8, 8192
    buffer_load_dwordx4 v[104:107], v112, s[12:15], s8 offen
    s_add_u32 s9, s9, 8192
    buffer_load_dwordx4 v[108:111], v112, s[12:15], s9 offen
    s_waitcnt vmcnt(8)
    v_mfma_f32_32x32x16_bf16 v[0:15], v[72:75], v[64:67], v[0:15]
    v_mfma_f32_32x32x16_bf16 v[16:31], v[72:75], v[68:71], v[16:31]
    v_mfma_f32_32x32x16_bf16 v[32:47], v[76:79], v[64:67], v[32:47]
    v_mfma_f32_32x32x16_bf16 v[48:63], v[76:79], v[68:71], v[48:63]
    s_add_u32 s6, s6, 8192
    buffer_load_dwordx4 v[64:67], v112, s[12:15], s6 offen
    s_add_u32 s7, s7, 8192
    buffer_load_dwordx4 v[68:71], v112, s[12:15], s7 offen
    s_add_u32 s8, s8, 8192
    buffer_load_dwordx4 v[72:75], v112, s[12:15], s8 offen
    s_add_u32 s9, s9, 8192
    buffer_load_dwordx4 v[76:79], v112, s[12:15], s9 offen
    s_waitcnt vmcnt(8)
    v_mfma_f32_32x32x16_bf16 v[0:15], v[88:91], v[80:83], v[0:15]
    v_mfma_f32_32x32x16_bf16 v[16:31], v[88:91], v[84:87], v[16:31]
    v_mfma_f32_32x32x16_bf16 v[32:47], v[92:95], v[80:83], v[32:47]
    v_mfma_f32_32x32x16_bf16 v[48:63], v[92:95], v[84:87], v[48:63]
    s_add_u32 s6, s6, 8192
    buffer_load_dwordx4 v[80:83], v112, s[12:15], s6 offen
    s_add_u32 s7, s7, 8192
    buffer_load_dwordx4 v[84:87], v112, s[12:15], s7 offen
    s_add_u32 s8, s8, 8192
    buffer_load_dwordx4 v[88:91], v112, s[12:15], s8 offen
    s_add_u32 s9, s9, 8192
    buffer_load_dwordx4 v[92:95], v112, s[12:15], s9 offen
    s_waitcnt vmcnt(8)
    v_mfma_f32_32x32x16_bf16 v[0:15], v[104:107], v[96:99], v[0:15]
    v_mfma_f32_32x32x16_bf16 v[16:31], v[104:107], v[100:103], v[16:31]
    v_mfma_f32_32x32x16_bf16 v[32:47], v[108:111], v[96:99], v[32:47]
    v_mfma_f32_32x32x16_bf16 v[48:63], v[108:111], v[100:103], v[48:63]
    s_add_u32 s6, s6, 8192
    buffer_load_dwordx4 v[96:99], v112, s[12:15], s6 offen
    s_add_u32 s7, s7, 8192
    buffer_load_dwordx4 v[100:103], v112, s[12:15], s7 offen
    s_add_u32 s8, s8, 8192
    buffer_load_dwordx4 v[104:107], v112, s[12:15], s8 offen
    s_add_u32 s9, s9, 8192
    buffer_load_dwordx4 v[108:111], v112, s[12:15], s9 offen
    s_waitcnt vmcnt(8)
    v_mfma_f32_32x32x16_bf16 v[0:15], v[72:75], v[64:67], v[0:15]
    v_mfma_f32_32x32x16_bf16 v[16:31], v[72:75], v[68:71], v[16:31]
    v_mfma_f32_32x32x16_bf16 v[32:47], v[76:79], v[64:67], v[32:47]
    v_mfma_f32_32x32x16_bf16 v[48:63], v[76:79], v[68:71], v[48:63]
    s_add_u32 s6, s6, 8192
    buffer_load_dwordx4 v[64:67], v112, s[12:15], s6 offen
    s_add_u32 s7, s7, 8192
    buffer_load_dwordx4 v[68:71], v112, s[12:15], s7 offen
    s_add_u32 s8, s8, 8192
    buffer_load_dwordx4 v[72:75], v112, s[12:15], s8 offen
    s_add_u32 s9, s9, 8192
    buffer_load_dwordx4 v[76:79], v112, s[12:15], s9 offen
    s_waitcnt vmcnt(8)
    v_mfma_f32_32x32x16_bf16 v[0:15], v[88:91], v[80:83], v[0:15]
    v_mfma_f32_32x32x16_bf16 v[16:31], v[88:91], v[84:87], v[16:31]
    v_mfma_f32_32x32x16_bf16 v[32:47], v[92:95], v[80:83], v[32:47]
    v_mfma_f32_32x32x16_bf16 v[48:63], v[92:95], v[84:87], v[48:63]
    s_add_u32 s6, s6, 8192
    buffer_load_dwordx4 v[80:83], v112, s[12:15], s6 offen
    s_add_u32 s7, s7, 8192
    buffer_load_dwordx4 v[84:87], v112, s[12:15], s7 offen
    s_add_u32 s8, s8, 8192
    buffer_load_dwordx4 v[88:91], v112, s[12:15], s8 offen
    s_add_u32 s9, s9, 8192
    buffer_load_dwordx4 v[92:95], v112, s[12:15], s9 offen
    s_waitcnt vmcnt(8)
    v_mfma_f32_32x32x16_bf16 v[0:15], v[104:107], v[96:99], v[0:15]
    v_mfma_f32_32x32x16_bf16 v[16:31], v[104:107], v[100:103], v[16:31]
    v_mfma_f32_32x32x16_bf16 v[32:47], v[108:111], v[96:99], v[32:47]
    v_mfma_f32_32x32x16_bf16 v[48:63], v[108:111], v[100:103], v[48:63]
    s_add_u32 s6, s6, 8192
    buffer_load_dwordx4 v[96:99], v112, s[12:15], s6 offen
    s_add_u32 s7, s7, 8192
    buffer_load_dwordx4 v[100:103], v112, s[12:15], s7 offen
    s_add_u32 s8, s8, 8192
    buffer_load_dwordx4 v[104:107], v112, s[12:15], s8 offen
    s_add_u32 s9, s9, 8192
    buffer_load_dwordx4 v[108:111], v112, s[12:15], s9 offen
    s_waitcnt vmcnt(8)
    v_mfma_f32_32x32x16_bf16 v[0:15], v[72:75], v[64:67], v[0:15]
    v_mfma_f32_32x32x16_bf16 v[16:31], v[72:75], v[68:71], v[16:31]
    v_mfma_f32_32x32x16_bf16 v[32:47], v[76:79], v[64:67], v[32:47]
    v_mfma_f32_32x32x16_bf16 v[48:63], v[76:79], v[68:71], v[48:63]
    s_add_u32 s6, s6, 8192
    buffer_load_dwordx4 v[64:67], v112, s[12:15], s6 offen
    s_add_u32 s7, s7, 8192
    buffer_load_dwordx4 v[68:71], v112, s[12:15], s7 offen
    s_add_u32 s8, s8, 8192
    buffer_load_dwordx4 v[72:75], v112, s[12:15], s8 offen
    s_add_u32 s9, s9, 8192
    buffer_load_dwordx4 v[76:79], v112, s[12:15], s9 offen
    s_waitcnt vmcnt(8)
    v_mfma_f32_32x32x16_bf16 v[0:15], v[88:91], v[80:83], v[0:15]
    v_mfma_f32_32x32x16_bf16 v[16:31], v[88:91], v[84:87], v[16:31]
    v_mfma_f32_32x32x16_bf16 v[32:47], v[92:95], v[80:83], v[32:47]
    v_mfma_f32_32x32x16_bf16 v[48:63], v[92:95], v[84:87], v[48:63]
    s_add_u32 s6, s6, 8192
    buffer_load_dwordx4 v[80:83], v112, s[12:15], s6 offen
    s_add_u32 s7, s7, 8192
    buffer_load_dwordx4 v[84:87], v112, s[12:15], s7 offen
    s_add_u32 s8, s8, 8192
    buffer_load_dwordx4 v[88:91], v112, s[12:15], s8 offen
    s_add_u32 s9, s9, 8192
    buffer_load_dwordx4 v[92:95], v112, s[12:15], s9 offen
    s_waitcnt vmcnt(8)
    v_mfma_f32_32x32x16_bf16 v[0:15], v[104:107], v[96:99], v[0:15]
    v_mfma_f32_32x32x16_bf16 v[16:31], v[104:107], v[100:103], v[16:31]
    v_mfma_f32_32x32x16_bf16 v[32:47], v[108:111], v[96:99], v[32:47]
    v_mfma_f32_32x32x16_bf16 v[48:63], v[108:111], v[100:103], v[48:63]
    s_add_u32 s6, s6, 8192
    buffer_load_dwordx4 v[96:99], v112, s[12:15], s6 offen
    s_add_u32 s7, s7, 8192
    buffer_load_dwordx4 v[100:103], v112, s[12:15], s7 offen
    s_add_u32 s8, s8, 8192
    buffer_load_dwordx4 v[104:107], v112, s[12:15], s8 offen
    s_add_u32 s9, s9, 8192
    buffer_load_dwordx4 v[108:111], v112, s[12:15], s9 offen
    s_waitcnt vmcnt(8)
    v_mfma_f32_32x32x16_bf16 v[0:15], v[72:75], v[64:67], v[0:15]
    v_mfma_f32_32x32x16_bf16 v[16:31], v[72:75], v[68:71], v[16:31]
    v_mfma_f32_32x32x16_bf16 v[32:47], v[76:79], v[64:67], v[32:47]
    v_mfma_f32_32x32x16_bf16 v[48:63], v[76:79], v[68:71], v[48:63]
    s_add_u32 s6, s6, 8192
    buffer_load_dwordx4 v[64:67], v112, s[12:15], s6 offen
    s_add_u32 s7, s7, 8192
    buffer_load_dwordx4 v[68:71], v112, s[12:15], s7 offen
    s_add_u32 s8, s8, 8192
    buffer_load_dwordx4 v[72:75], v112, s[12:15], s8 offen
    s_add_u32 s9, s9, 8192
    buffer_load_dwordx4 v[76:79], v112, s[12:15], s9 offen
    s_waitcnt vmcnt(8)
    v_mfma_f32_32x32x16_bf16 v[0:15], v[88:91], v[80:83], v[0:15]
    v_mfma_f32_32x32x16_bf16 v[16:31], v[88:91], v[84:87], v[16:31]
    v_mfma_f32_32x32x16_bf16 v[32:47], v[92:95], v[80:83], v[32:47]
    v_mfma_f32_32x32x16_bf16 v[48:63], v[92:95], v[84:87], v[48:63]
    s_add_u32 s6, s6, 8192
    buffer_load_dwordx4 v[80:83], v112, s[12:15], s6 offen
    s_add_u32 s7, s7, 8192
    buffer_load_dwordx4 v[84:87], v112, s[12:15], s7 offen
    s_add_u32 s8, s8, 8192
    buffer_load_dwordx4 v[88:91], v112, s[12:15], s8 offen
    s_add_u32 s9, s9, 8192
    buffer_load_dwordx4 v[92:95], v112, s[12:15], s9 offen
    s_waitcnt vmcnt(8)
    v_mfma_f32_32x32x16_bf16 v[0:15], v[104:107], v[96:99], v[0:15]
    v_mfma_f32_32x32x16_bf16 v[16:31], v[104:107], v[100:103], v[16:31]
    v_mfma_f32_32x32x16_bf16 v[32:47], v[108:111], v[96:99], v[32:47]
    v_mfma_f32_32x32x16_bf16 v[48:63], v[108:111], v[100:103], v[48:63]
    s_add_u32 s6, s6, 8192
    buffer_load_dwordx4 v[96:99], v112, s[12:15], s6 offen
    s_add_u32 s7, s7, 8192
    buffer_load_dwordx4 v[100:103], v112, s[12:15], s7 offen
    s_add_u32 s8, s8, 8192
    buffer_load_dwordx4 v[104:107], v112, s[12:15], s8 offen
    s_add_u32 s9, s9, 8192
    buffer_load_dwordx4 v[108:111], v112, s[12:15], s9 offen
    s_waitcnt vmcnt(8)
    v_mfma_f32_32x32x16_bf16 v[0:15], v[72:75], v[64:67], v[0:15]
    v_mfma_f32_32x32x16_bf16 v[16:31], v[72:75], v[68:71], v[16:31]
    v_mfma_f32_32x32x16_bf16 v[32:47], v[76:79], v[64:67], v[32:47]
    v_mfma_f32_32x32x16_bf16 v[48:63], v[76:79], v[68:71], v[48:63]
    s_add_u32 s6, s6, 8192
    buffer_load_dwordx4 v[64:67], v112, s[12:15], s6 offen
    s_add_u32 s7, s7, 8192
    buffer_load_dwordx4 v[68:71], v112, s[12:15], s7 offen
    s_add_u32 s8, s8, 8192
    buffer_load_dwordx4 v[72:75], v112, s[12:15], s8 offen
    s_add_u32 s9, s9, 8192
    buffer_load_dwordx4 v[76:79], v112, s[12:15], s9 offen
    s_waitcnt vmcnt(8)
    v_mfma_f32_32x32x16_bf16 v[0:15], v[88:91], v[80:83], v[0:15]
    v_mfma_f32_32x32x16_bf16 v[16:31], v[88:91], v[84:87], v[16:31]
    v_mfma_f32_32x32x16_bf16 v[32:47], v[92:95], v[80:83], v[32:47]
    v_mfma_f32_32x32x16_bf16 v[48:63], v[92:95], v[84:87], v[48:63]
    s_add_u32 s6, s6, 8192
    buffer_load_dwordx4 v[80:83], v112, s[12:15], s6 offen
    s_add_u32 s7, s7, 8192
    buffer_load_dwordx4 v[84:87], v112, s[12:15], s7 offen
    s_add_u32 s8, s8, 8192
    buffer_load_dwordx4 v[88:91], v112, s[12:15], s8 offen
    s_add_u32 s9, s9, 8192
    buffer_load_dwordx4 v[92:95], v112, s[12:15], s9 offen
    s_waitcnt vmcnt(8)
    v_mfma_f32_32x32x16_bf16 v[0:15], v[104:107], v[96:99], v[0:15]
    v_mfma_f32_32x32x16_bf16 v[16:31], v[104:107], v[100:103], v[16:31]
    v_mfma_f32_32x32x16_bf16 v[32:47], v[108:111], v[96:99], v[32:47]
    v_mfma_f32_32x32x16_bf16 v[48:63], v[108:111], v[100:103], v[48:63]
    s_add_u32 s6, s6, 8192
    buffer_load_dwordx4 v[96:99], v112, s[12:15], s6 offen
    s_add_u32 s7, s7, 8192
    buffer_load_dwordx4 v[100:103], v112, s[12:15], s7 offen
    s_add_u32 s8, s8, 8192
    buffer_load_dwordx4 v[104:107], v112, s[12:15], s8 offen
    s_add_u32 s9, s9, 8192
    buffer_load_dwordx4 v[108:111], v112, s[12:15], s9 offen
    s_waitcnt vmcnt(8)
    v_mfma_f32_32x32x16_bf16 v[0:15], v[72:75], v[64:67], v[0:15]
    v_mfma_f32_32x32x16_bf16 v[16:31], v[72:75], v[68:71], v[16:31]
    v_mfma_f32_32x32x16_bf16 v[32:47], v[76:79], v[64:67], v[32:47]
    v_mfma_f32_32x32x16_bf16 v[48:63], v[76:79], v[68:71], v[48:63]
    s_add_u32 s6, s6, 8192
    buffer_load_dwordx4 v[64:67], v112, s[12:15], s6 offen
    s_add_u32 s7, s7, 8192
    buffer_load_dwordx4 v[68:71], v112, s[12:15], s7 offen
    s_add_u32 s8, s8, 8192
    buffer_load_dwordx4 v[72:75], v112, s[12:15], s8 offen
    s_add_u32 s9, s9, 8192
    buffer_load_dwordx4 v[76:79], v112, s[12:15], s9 offen
    s_waitcnt vmcnt(8)
    v_mfma_f32_32x32x16_bf16 v[0:15], v[88:91], v[80:83], v[0:15]
    v_mfma_f32_32x32x16_bf16 v[16:31], v[88:91], v[84:87], v[16:31]
    v_mfma_f32_32x32x16_bf16 v[32:47], v[92:95], v[80:83], v[32:47]
    v_mfma_f32_32x32x16_bf16 v[48:63], v[92:95], v[84:87], v[48:63]
    s_add_u32 s6, s6, 8192
    buffer_load_dwordx4 v[80:83], v112, s[12:15], s6 offen
    s_add_u32 s7, s7, 8192
    buffer_load_dwordx4 v[84:87], v112, s[12:15], s7 offen
    s_add_u32 s8, s8, 8192
    buffer_load_dwordx4 v[88:91], v112, s[12:15], s8 offen
    s_add_u32 s9, s9, 8192
    buffer_load_dwordx4 v[92:95], v112, s[12:15], s9 offen
    s_waitcnt vmcnt(8)
    v_mfma_f32_32x32x16_bf16 v[0:15], v[104:107], v[96:99], v[0:15]
    v_mfma_f32_32x32x16_bf16 v[16:31], v[104:107], v[100:103], v[16:31]
    v_mfma_f32_32x32x16_bf16 v[32:47], v[108:111], v[96:99], v[32:47]
    v_mfma_f32_32x32x16_bf16 v[48:63], v[108:111], v[100:103], v[48:63]
    s_add_u32 s6, s6, 8192
    buffer_load_dwordx4 v[96:99], v112, s[12:15], s6 offen
    s_add_u32 s7, s7, 8192
    buffer_load_dwordx4 v[100:103], v112, s[12:15], s7 offen
    s_add_u32 s8, s8, 8192
    buffer_load_dwordx4 v[104:107], v112, s[12:15], s8 offen
    s_add_u32 s9, s9, 8192
    buffer_load_dwordx4 v[108:111], v112, s[12:15], s9 offen
    s_waitcnt vmcnt(8)
    v_mfma_f32_32x32x16_bf16 v[0:15], v[72:75], v[64:67], v[0:15]
    v_mfma_f32_32x32x16_bf16 v[16:31], v[72:75], v[68:71], v[16:31]
    v_mfma_f32_32x32x16_bf16 v[32:47], v[76:79], v[64:67], v[32:47]
    v_mfma_f32_32x32x16_bf16 v[48:63], v[76:79], v[68:71], v[48:63]
    s_add_u32 s6, s6, 8192
    buffer_load_dwordx4 v[64:67], v112, s[12:15], s6 offen
    s_add_u32 s7, s7, 8192
    buffer_load_dwordx4 v[68:71], v112, s[12:15], s7 offen
    s_add_u32 s8, s8, 8192
    buffer_load_dwordx4 v[72:75], v112, s[12:15], s8 offen
    s_add_u32 s9, s9, 8192
    buffer_load_dwordx4 v[76:79], v112, s[12:15], s9 offen
    s_waitcnt vmcnt(8)
    v_mfma_f32_32x32x16_bf16 v[0:15], v[88:91], v[80:83], v[0:15]
    v_mfma_f32_32x32x16_bf16 v[16:31], v[88:91], v[84:87], v[16:31]
    v_mfma_f32_32x32x16_bf16 v[32:47], v[92:95], v[80:83], v[32:47]
    v_mfma_f32_32x32x16_bf16 v[48:63], v[92:95], v[84:87], v[48:63]
    s_add_u32 s6, s6, 8192
    buffer_load_dwordx4 v[80:83], v112, s[12:15], s6 offen
    s_add_u32 s7, s7, 8192
    buffer_load_dwordx4 v[84:87], v112, s[12:15], s7 offen
    s_add_u32 s8, s8, 8192
    buffer_load_dwordx4 v[88:91], v112, s[12:15], s8 offen
    s_add_u32 s9, s9, 8192
    buffer_load_dwordx4 v[92:95], v112, s[12:15], s9 offen
    s_waitcnt vmcnt(8)
    v_mfma_f32_32x32x16_bf16 v[0:15], v[104:107], v[96:99], v[0:15]
    v_mfma_f32_32x32x16_bf16 v[16:31], v[104:107], v[100:103], v[16:31]
    v_mfma_f32_32x32x16_bf16 v[32:47], v[108:111], v[96:99], v[32:47]
    v_mfma_f32_32x32x16_bf16 v[48:63], v[108:111], v[100:103], v[48:63]
    s_add_u32 s6, s6, 8192
    buffer_load_dwordx4 v[96:99], v112, s[12:15], s6 offen
    s_add_u32 s7, s7, 8192
    buffer_load_dwordx4 v[100:103], v112, s[12:15], s7 offen
    s_add_u32 s8, s8, 8192
    buffer_load_dwordx4 v[104:107], v112, s[12:15], s8 offen
    s_add_u32 s9, s9, 8192
    buffer_load_dwordx4 v[108:111], v112, s[12:15], s9 offen
    s_waitcnt vmcnt(8)
    v_mfma_f32_32x32x16_bf16 v[0:15], v[72:75], v[64:67], v[0:15]
    v_mfma_f32_32x32x16_bf16 v[16:31], v[72:75], v[68:71], v[16:31]
    v_mfma_f32_32x32x16_bf16 v[32:47], v[76:79], v[64:67], v[32:47]
    v_mfma_f32_32x32x16_bf16 v[48:63], v[76:79], v[68:71], v[48:63]
    s_add_u32 s6, s6, 8192
    buffer_load_dwordx4 v[64:67], v112, s[12:15], s6 offen
    s_add_u32 s7, s7, 8192
    buffer_load_dwordx4 v[68:71], v112, s[12:15], s7 offen
    s_add_u32 s8, s8, 8192
    buffer_load_dwordx4 v[72:75], v112, s[12:15], s8 offen
    s_add_u32 s9, s9, 8192
    buffer_load_dwordx4 v[76:79], v112, s[12:15], s9 offen
    s_waitcnt vmcnt(8)
    v_mfma_f32_32x32x16_bf16 v[0:15], v[88:91], v[80:83], v[0:15]
    v_mfma_f32_32x32x16_bf16 v[16:31], v[88:91], v[84:87], v[16:31]
    v_mfma_f32_32x32x16_bf16 v[32:47], v[92:95], v[80:83], v[32:47]
    v_mfma_f32_32x32x16_bf16 v[48:63], v[92:95], v[84:87], v[48:63]
    s_add_u32 s6, s6, 8192
    buffer_load_dwordx4 v[80:83], v112, s[12:15], s6 offen
    s_add_u32 s7, s7, 8192
    buffer_load_dwordx4 v[84:87], v112, s[12:15], s7 offen
    s_add_u32 s8, s8, 8192
    buffer_load_dwordx4 v[88:91], v112, s[12:15], s8 offen
    s_add_u32 s9, s9, 8192
    buffer_load_dwordx4 v[92:95], v112, s[12:15], s9 offen
    s_waitcnt vmcnt(8)
    v_mfma_f32_32x32x16_bf16 v[0:15], v[104:107], v[96:99], v[0:15]
    v_mfma_f32_32x32x16_bf16 v[16:31], v[104:107], v[100:103], v[16:31]
    v_mfma_f32_32x32x16_bf16 v[32:47], v[108:111], v[96:99], v[32:47]
    v_mfma_f32_32x32x16_bf16 v[48:63], v[108:111], v[100:103], v[48:63]
    s_waitcnt vmcnt(4)
    v_mfma_f32_32x32x16_bf16 v[0:15], v[72:75], v[64:67], v[0:15]
    v_mfma_f32_32x32x16_bf16 v[16:31], v[72:75], v[68:71], v[16:31]
    v_mfma_f32_32x32x16_bf16 v[32:47], v[76:79], v[64:67], v[32:47]
    v_mfma_f32_32x32x16_bf16 v[48:63], v[76:79], v[68:71], v[48:63]
    s_waitcnt vmcnt(0)
    v_mfma_f32_32x32x16_bf16 v[0:15], v[88:91], v[80:83], v[0:15]
    v_mfma_f32_32x32x16_bf16 v[16:31], v[88:91], v[84:87], v[16:31]
    v_mfma_f32_32x32x16_bf16 v[32:47], v[92:95], v[80:83], v[32:47]
    v_mfma_f32_32x32x16_bf16 v[48:63], v[92:95], v[84:87], v[48:63]
    s_and_b32 s22, s3, 3
    s_lshl_b32 s22, s22, 14
    v_add_u32 v113, s22, v112
    s_cmp_lt_u32 s3, 4
    s_nop 6
    s_cbranch_scc1 L_k3_r1
    ds_write_b128 v113, v[0:3] offset:0
    ds_write_b128 v113, v[4:7] offset:1024
    ds_write_b128 v113, v[8:11] offset:2048
    ds_write_b128 v113, v[12:15] offset:3072
    ds_write_b128 v113, v[16:19] offset:4096
    ds_write_b128 v113, v[20:23] offset:5120
    ds_write_b128 v113, v[24:27] offset:6144
    ds_write_b128 v113, v[28:31] offset:7168
    ds_write_b128 v113, v[32:35] offset:8192
    ds_write_b128 v113, v[36:39] offset:9216
    ds_write_b128 v113, v[40:43] offset:10240
    ds_write_b128 v113, v[44:47] offset:11264
    ds_write_b128 v113, v[48:51] offset:12288
    ds_write_b128 v113, v[52:55] offset:13312
    ds_write_b128 v113, v[56:59] offset:14336
    ds_write_b128 v113, v[60:63] offset:15360
    s_waitcnt lgkmcnt(0)
    s_barrier
    s_barrier
    s_branch L_k3_r2
L_k3_r1:
    s_barrier
    ds_read_b128 v[64:67], v113 offset:0
    ds_read_b128 v[68:71], v113 offset:1024
    ds_read_b128 v[72:75], v113 offset:2048
    ds_read_b128 v[76:79], v113 offset:3072
    ds_read_b128 v[80:83], v113 offset:4096
    ds_read_b128 v[84:87], v113 offset:5120
    ds_read_b128 v[88:91], v113 offset:6144
    ds_read_b128 v[92:95], v113 offset:7168
    s_waitcnt lgkmcnt(0)
    v_add_f32 v0, v0, v64
    v_add_f32 v1, v1, v65
    v_add_f32 v2, v2, v66
    v_add_f32 v3, v3, v67
    v_add_f32 v4, v4, v68
    v_add_f32 v5, v5, v69
    v_add_f32 v6, v6, v70
    v_add_f32 v7, v7, v71
    v_add_f32 v8, v8, v72
    v_add_f32 v9, v9, v73
    v_add_f32 v10, v10, v74
    v_add_f32 v11, v11, v75
    v_add_f32 v12, v12, v76
    v_add_f32 v13, v13, v77
    v_add_f32 v14, v14, v78
    v_add_f32 v15, v15, v79
    v_add_f32 v16, v16, v80
    v_add_f32 v17, v17, v81
    v_add_f32 v18, v18, v82
    v_add_f32 v19, v19, v83
    v_add_f32 v20, v20, v84
    v_add_f32 v21, v21, v85
    v_add_f32 v22, v22, v86
    v_add_f32 v23, v23, v87
    v_add_f32 v24, v24, v88
    v_add_f32 v25, v25, v89
    v_add_f32 v26, v26, v90
    v_add_f32 v27, v27, v91
    v_add_f32 v28, v28, v92
    v_add_f32 v29, v29, v93
    v_add_f32 v30, v30, v94
    v_add_f32 v31, v31, v95
    ds_read_b128 v[64:67], v113 offset:8192
    ds_read_b128 v[68:71], v113 offset:9216
    ds_read_b128 v[72:75], v113 offset:10240
    ds_read_b128 v[76:79], v113 offset:11264
    ds_read_b128 v[80:83], v113 offset:12288
    ds_read_b128 v[84:87], v113 offset:13312
    ds_read_b128 v[88:91], v113 offset:14336
    ds_read_b128 v[92:95], v113 offset:15360
    s_waitcnt lgkmcnt(0)
    v_add_f32 v32, v32, v64
    v_add_f32 v33, v33, v65
    v_add_f32 v34, v34, v66
    v_add_f32 v35, v35, v67
    v_add_f32 v36, v36, v68
    v_add_f32 v37, v37, v69
    v_add_f32 v38, v38, v70
    v_add_f32 v39, v39, v71
    v_add_f32 v40, v40, v72
    v_add_f32 v41, v41, v73
    v_add_f32 v42, v42, v74
    v_add_f32 v43, v43, v75
    v_add_f32 v44, v44, v76
    v_add_f32 v45, v45, v77
    v_add_f32 v46, v46, v78
    v_add_f32 v47, v47, v79
    v_add_f32 v48, v48, v80
    v_add_f32 v49, v49, v81
    v_add_f32 v50, v50, v82
    v_add_f32 v51, v51, v83
    v_add_f32 v52, v52, v84
    v_add_f32 v53, v53, v85
    v_add_f32 v54, v54, v86
    v_add_f32 v55, v55, v87
    v_add_f32 v56, v56, v88
    v_add_f32 v57, v57, v89
    v_add_f32 v58, v58, v90
    v_add_f32 v59, v59, v91
    v_add_f32 v60, v60, v92
    v_add_f32 v61, v61, v93
    v_add_f32 v62, v62, v94
    v_add_f32 v63, v63, v95
    ds_write_b128 v113, v[0:3] offset:0
    ds_write_b128 v113, v[4:7] offset:1024
    ds_write_b128 v113, v[8:11] offset:2048
    ds_write_b128 v113, v[12:15] offset:3072
    ds_write_b128 v113, v[16:19] offset:4096
    ds_write_b128 v113, v[20:23] offset:5120
    ds_write_b128 v113, v[24:27] offset:6144
    ds_write_b128 v113, v[28:31] offset:7168
    ds_write_b128 v113, v[32:35] offset:8192
    ds_write_b128 v113, v[36:39] offset:9216
    ds_write_b128 v113, v[40:43] offset:10240
    ds_write_b128 v113, v[44:47] offset:11264
    ds_write_b128 v113, v[48:51] offset:12288
    ds_write_b128 v113, v[52:55] offset:13312
    ds_write_b128 v113, v[56:59] offset:14336
    ds_write_b128 v113, v[60:63] offset:15360
    s_waitcnt lgkmcnt(0)
    s_barrier
L_k3_r2:
    s_lshl_b32 s22, s3, 11
    v_add_u32 v113, s22, v112
    ds_read_b128 v[64:67], v113 offset:0
    ds_read_b128 v[68:71], v113 offset:1024
    ds_read_b128 v[72:75], v113 offset:16384
    ds_read_b128 v[76:79], v113 offset:17408
    ds_read_b128 v[80:83], v113 offset:32768
    ds_read_b128 v[84:87], v113 offset:33792
    ds_read_b128 v[88:91], v113 offset:49152
    ds_read_b128 v[92:95], v113 offset:50176
    s_waitcnt lgkmcnt(0)
    v_add_f32 v64, v64, v80
    v_add_f32 v65, v65, v81
    v_add_f32 v66, v66, v82
    v_add_f32 v67, v67, v83
    v_add_f32 v68, v68, v84
    v_add_f32 v69, v69, v85
    v_add_f32 v70, v70, v86
    v_add_f32 v71, v71, v87
    v_add_f32 v72, v72, v88
    v_add_f32 v73, v73, v89
    v_add_f32 v74, v74, v90
    v_add_f32 v75, v75, v91
    v_add_f32 v76, v76, v92
    v_add_f32 v77, v77, v93
    v_add_f32 v78, v78, v94
    v_add_f32 v79, v79, v95
    v_add_f32 v64, v64, v72
    v_add_f32 v65, v65, v73
    v_add_f32 v66, v66, v74
    v_add_f32 v67, v67, v75
    v_add_f32 v68, v68, v76
    v_add_f32 v69, v69, v77
    v_add_f32 v70, v70, v78
    v_add_f32 v71, v71, v79
    v_cvt_pk_bf16_f32 v0, v64, v65
    v_cvt_pk_bf16_f32 v1, v66, v67
    v_cvt_pk_bf16_f32 v2, v68, v69
    v_cvt_pk_bf16_f32 v3, v70, v71
    s_nop 0
    v_permlane32_swap_b32 v0, v2
    v_permlane32_swap_b32 v1, v3
    s_lshr_b32 s22, s3, 1
    s_and_b32 s23, s22, 1
    s_lshl_b32 s23, s23, 16
    s_lshl_b32 s24, s4, 17
    s_add_u32 s23, s23, s24
    s_lshr_b32 s22, s22, 1
    s_lshl_b32 s22, s22, 6
    s_add_u32 s23, s23, s22
    s_and_b32 s22, s3, 1
    s_lshl_b32 s22, s22, 5
    s_add_u32 s23, s23, s22
    s_lshl_b32 s22, s5, 7
    s_add_u32 s23, s23, s22
    buffer_store_dwordx4 v[0:3], v114, s[16:19], s23 offen
    s_nop 1
L_k34_end:
    s_endpgm
.section .rodata,"a"
.p2align 6
.amdhsa_kernel k1_proj_kernel
  .amdhsa_next_free_vgpr 256
  .amdhsa_next_free_sgpr 80
  .amdhsa_accum_offset 256
  .amdhsa_group_segment_fixed_size 0
  .amdhsa_kernarg_size 144
  .amdhsa_user_sgpr_count 2
  .amdhsa_user_sgpr_kernarg_segment_ptr 1
  .amdhsa_system_sgpr_workgroup_id_x 1
.end_amdhsa_kernel
.p2align 6
.amdhsa_kernel k2_attn_kernel
  .amdhsa_next_free_vgpr 256
  .amdhsa_next_free_sgpr 80
  .amdhsa_accum_offset 256
  .amdhsa_group_segment_fixed_size 0
  .amdhsa_kernarg_size 144
  .amdhsa_user_sgpr_count 2
  .amdhsa_user_sgpr_kernarg_segment_ptr 1
  .amdhsa_system_sgpr_workgroup_id_x 1
.end_amdhsa_kernel
.p2align 6
.amdhsa_kernel k3_out_kernel
  .amdhsa_next_free_vgpr 128
  .amdhsa_next_free_sgpr 80
  .amdhsa_accum_offset 128
  .amdhsa_group_segment_fixed_size 0
  .amdhsa_kernarg_size 144
  .amdhsa_user_sgpr_count 2
  .amdhsa_user_sgpr_kernarg_segment_ptr 1
  .amdhsa_system_sgpr_workgroup_id_x 1
.end_amdhsa_kernel
```
